```python
import torch

def _softmax(x, axis=-1):
    return torch.softmax(x, dim=axis)
def _gelu(x):
    return torch.nn.functional.gelu(x, approximate="tanh")
def _silu(x):
    return torch.nn.functional.silu(x)
def _sigmoid(x):
    return torch.sigmoid(x)
def _layernorm(x, axis=-1, eps=1e-5):
    m = x.mean(dim=axis, keepdim=True)
    v = x.var(dim=axis, keepdim=True, unbiased=False)
    return (x - m) / torch.sqrt(v + eps)
def _scatter_add(tgt, idx, src, axis=0):
    return tgt.clone().index_add_(axis, idx, src)
def _segment_sum(src, seg, n):
    out = torch.zeros((n,) + src.shape[1:], dtype=src.dtype)
    return out.index_add_(0, seg, src)
def _pad(x, pw):
    flat = tuple(v for pair in reversed(pw) for v in pair)
    return torch.nn.functional.pad(x, flat)

kernel_name = 'parallel_sum__linear_attn_block__dense_activation_relu__prompt'

def setup_inputs():

    _w = (lambda a: (lambda t: t.to(torch.bfloat16) if t.is_floating_point() else t)(torch.as_tensor(a)))
    def _A_setup():
        B, S, D = 1, 2048, 512
        return {
            "x": _w((lambda *s: torch.randn(*s, dtype=torch.bfloat16) * 0.05)(B, S, D)),
            "wqkv": _w((lambda *s: torch.randn(*s, dtype=torch.bfloat16) * 0.2)(D, 3 * D)),
            "wo": _w((lambda *s: torch.randn(*s, dtype=torch.bfloat16) * 0.2)(D, D)),
        }
    _A_in = _A_setup()

    def _B_setup():
        B, S, D, Dff = 1, 2048, 512, 1376
        return {
            "x": _w((lambda *s: torch.randn(*s, dtype=torch.bfloat16) * 0.05)(B, S, D)),
            "w1": _w((lambda *s: torch.randn(*s, dtype=torch.bfloat16) * 0.05)(D, Dff)),
            "w2": _w((lambda *s: torch.randn(*s, dtype=torch.bfloat16) * 0.05)(Dff, D)),
        }
    _B_in = _B_setup()

    return {
        "A_x": _A_in["x"],
        "A_wqkv": _A_in["wqkv"],
        "A_wo": _A_in["wo"],
        "B_x": _B_in["x"],
        "B_w1": _B_in["w1"],
        "B_w2": _B_in["w2"],
    }

def reference(A_x, A_wqkv, A_wo, B_x, B_w1, B_w2):
    def _A_ref(x, wqkv, wo):
        B, S, D = x.shape
        H = 32; Dh = D // H
        qkv = (lambda x, *d: x.permute(*d))((x @ wqkv).reshape(B, S, 3, H, Dh), 2, 0, 3, 1, 4)
        q, k, v = qkv[0], qkv[1], qkv[2]
        phi = lambda t: torch.where(t > 0, t + 1, torch.exp(t)) + 1e-6
        pq, pk = phi(q), phi(k)
        kv = torch.einsum("bhsd,bhse->bhde", pk, v)
        z = torch.einsum("bhsd->bhd", pk)
        num = torch.einsum("bhqd,bhde->bhqe", pq, kv)
        den = torch.einsum("bhqd,bhd->bhq", pq, z)[..., None] + 1e-6
        o = num / den
        return (lambda x, *d: x.permute(*d))(o, 0, 2, 1, 3).reshape(B, S, D) @ wo

    def _B_ref(x, w1, w2):
        h = torch.einsum("bsd,df->bsf", x, w1)
        zero = torch.zeros_like(h)
        h = torch.maximum(h, zero)
        return torch.einsum("bsf,fd->bsd", h, w2)

    x = A_x
    xn = _layernorm(x, axis=-1)
    return x + _A_ref(xn, A_wqkv, A_wo) + _B_ref(xn, B_w1, B_w2)
```

```asm
; @launch grid=(256,1,1) block=(256,1,1) lds=163840
.amdgcn_target "amdgcn-amd-amdhsa--gfx950"
.text
.set CODE_LAST, L_code_end - L_pc - 4
.globl parallel_sum__linear_attn_block__dense_activation_relu__prompt_kernel
.p2align 8
.type parallel_sum__linear_attn_block__dense_activation_relu__prompt_kernel,@function
parallel_sum__linear_attn_block__dense_activation_relu__prompt_kernel:
  s_cmp_ge_u32 s2, 256
  s_cbranch_scc1 L_end
  s_load_dwordx16 s[4:19], s[0:1], 0
  s_load_dwordx2 s[20:21], s[0:1], 64
  s_getpc_b64 s[72:73]
L_pc:
  s_bfe_u32 s74, s2, 0x20003
  s_mul_i32 s74, s74, 80
  v_lshrrev_b32 v13, 6, v0
  v_mul_u32_u24 v13, 20, v13
  v_and_b32 v14, 63, v0
  v_min_u32 v14, 19, v14
  v_add3_u32 v13, v13, v14, s74
  v_lshlrev_b32 v13, 7, v13
  v_min_u32 v13, CODE_LAST, v13
  global_load_dword v255, v13, s[72:73]
  v_and_b32 v1, 63, v0
  v_lshrrev_b32 v13, 6, v0
  s_and_b32 s72, s2, 7
  s_lshr_b32 s73, s2, 3
  v_readfirstlane_b32 s24, v13
  s_and_b32 s22, s72, 1
  s_lshl_b32 s22, s22, 3
  s_and_b32 s74, s73, 7
  s_add_u32 s22, s22, s74
  s_and_b32 s23, s72, 6
  s_bfe_u32 s74, s73, 0x10003
  s_add_u32 s23, s23, s74
  s_lshr_b32 s74, s73, 4
  s_lshl_b32 s74, s74, 3
  s_add_u32 s23, s23, s74
  s_lshl_b32 s66, s72, 2
  s_and_b32 s74, s73, 3
  s_add_u32 s66, s66, s74
  s_lshr_b32 s67, s73, 2
  s_lshr_b32 s25, s24, 1
  s_and_b32 s26, s24, 1
  v_lshrrev_b32 v13, 2, v1
  v_and_b32 v13, 7, v13
  s_lshl_b32 s72, s24, 3
  v_add_u32 v15, s72, v13
  v_and_b32 v14, 3, v1
  s_lshl_b32 s72, s26, 1
  v_xor_b32 v14, s72, v14
  v_lshlrev_b32 v14, 4, v14
  v_lshrrev_b32 v3, 5, v1
  v_lshlrev_b32 v3, 6, v3
  v_add_u32 v14, v14, v3
  v_lshlrev_b32 v2, 10, v15
  v_add_u32 v2, v2, v14
  s_cmp_lt_u32 s23, 8
  s_movk_i32 s56, 2752
  s_cselect_b32 s56, 3072, s56
  v_mul_lo_u32 v3, v15, s56
  v_add_u32 v3, v3, v14
  s_lshl_b32 s59, s56, 6
  s_lshl_b32 s57, s22, 17
  s_lshr_b32 s76, s2, 6
  s_lshl_b32 s76, s76, 1
  s_add_u32 s76, s76, s22
  s_and_b32 s76, s76, 7
  s_lshl_b32 s27, s24, 10
  s_lshl_b32 s72, s23, 7
  s_sub_u32 s73, s23, 8
  s_mul_i32 s73, s73, 384
  s_cmp_lt_u32 s23, 8
  s_cselect_b32 s60, s72, s73
  s_movk_i32 s72, 128
  s_cselect_b32 s72, 1024, s72
  s_add_u32 s61, s60, s72
  s_add_u32 s62, s61, s72
  s_lshl_b32 s72, s56, 5
  s_add_u32 s63, s60, s72
  s_add_u32 s64, s61, s72
  s_add_u32 s65, s62, s72
  s_mov_b32 s30, 0x200000
  s_mov_b32 s31, 0x20000
  s_mov_b32 s34, 1409024
  s_mul_i32 s58, s76, s59
  s_lshl_b32 s77, s76, 7
  s_add_u32 s77, s77, s57
  s_cmp_lt_u32 s23, 8
  s_cselect_b32 s34, 0x180000, s34
  s_mov_b32 s35, 0x20000
  s_waitcnt lgkmcnt(0)
  s_mov_b32 s28, s4
  s_mov_b32 s29, s5
  s_cselect_b32 s32, s6, s12
  s_cselect_b32 s33, s7, s13
  s_mov_b32 s36, s20
  s_mov_b32 s37, s21
  s_mov_b32 s20, s76
  s_mov_b32 s21, s77
  s_add_u32 m0, s27, 0
  s_add_u32 s4, s21, 0
  buffer_load_dwordx4 v2, s[28:31], s4 offen lds
  s_add_u32 m0, s27, 49152
  s_add_u32 s4, s58, s60
  buffer_load_dwordx4 v3, s[32:35], s4 offen lds
  s_add_u32 m0, s27, 57344
  s_add_u32 s4, s58, s61
  buffer_load_dwordx4 v3, s[32:35], s4 offen lds
  s_add_u32 m0, s27, 4096
  s_add_u32 s4, s21, 32768
  buffer_load_dwordx4 v2, s[28:31], s4 offen lds
  s_add_u32 m0, s27, 65536
  s_add_u32 s4, s58, s62
  buffer_load_dwordx4 v3, s[32:35], s4 offen lds
  s_add_u32 m0, s27, 8192
  s_add_u32 s4, s21, 65536
  buffer_load_dwordx4 v2, s[28:31], s4 offen lds
  s_add_u32 m0, s27, 53248
  s_add_u32 s4, s58, s63
  buffer_load_dwordx4 v3, s[32:35], s4 offen lds
  s_add_u32 m0, s27, 61440
  s_add_u32 s4, s58, s64
  buffer_load_dwordx4 v3, s[32:35], s4 offen lds
  s_add_u32 m0, s27, 12288
  s_add_u32 s4, s21, 98304
  buffer_load_dwordx4 v2, s[28:31], s4 offen lds
  s_add_u32 m0, s27, 69632
  s_add_u32 s4, s58, s65
  buffer_load_dwordx4 v3, s[32:35], s4 offen lds
  s_add_u32 s20, s20, 1
  s_and_b32 s20, s20, 7
  s_mul_i32 s58, s20, s59
  s_lshl_b32 s21, s20, 7
  s_add_u32 s21, s21, s57
  s_mov_b32 s38, 8491008
  s_mov_b32 s39, 0x20000
  s_mov_b32 s40, s14
  s_mov_b32 s41, s15
  s_mov_b32 s42, 1409024
  s_mov_b32 s43, 0x20000
  s_mov_b32 s44, s8
  s_mov_b32 s45, s9
  s_mov_b32 s46, 524288
  s_mov_b32 s47, 0x20000
  s_mov_b32 s48, s16
  s_mov_b32 s49, s17
  s_mov_b32 s50, 2097152
  s_mov_b32 s51, 0x20000
  s_mov_b32 s52, s18
  s_mov_b32 s53, s19
  s_mov_b32 s54, 256
  s_mov_b32 s55, 0x20000
  v_lshrrev_b32 v20, 3, v1
  v_and_b32 v20, 1, v20
  v_lshrrev_b32 v21, 4, v1
  v_lshlrev_b32 v22, 1, v20
  v_xor_b32 v22, v22, v21
  v_lshlrev_b32 v22, 4, v22
  v_lshlrev_b32 v23, 10, v20
  v_add_u32 v22, v22, v23
  v_and_b32 v23, 7, v1
  v_lshlrev_b32 v23, 6, v23
  v_add_u32 v22, v22, v23
  s_lshl_b32 s72, s25, 13
  s_lshl_b32 s73, s26, 12
  s_add_u32 s74, s72, s73
  s_sub_u32 s75, s72, s73
  s_add_u32 s75, s75, 4096
  v_add_u32 v4, s74, v22
  v_add_u32 v5, s75, v22
  v_lshrrev_b32 v23, 2, v1
  v_and_b32 v23, 3, v23
  v_lshlrev_b32 v23, 6, v23
  v_and_b32 v24, 3, v1
  v_cmp_eq_u32 s[94:95], 1, v24
  v_cmp_eq_u32 s[96:97], 2, v24
  v_cmp_eq_u32 s[98:99], 3, v24
  v_lshlrev_b32 v24, 3, v24
  v_add_u32 v24, v24, v23
  v_lshlrev_b32 v22, 10, v21
  v_add_u32 v22, v22, v24
  s_lshl_b32 s72, s26, 9
  s_add_u32 s72, s72, 49152
  v_add_u32 v22, s72, v22
  v_and_b32 v25, 1, v21
  v_lshlrev_b32 v23, 5, v25
  v_add_u32 v6, v22, v23
  v_xor_b32 v26, 32, v23
  v_add_u32 v7, v22, v26
  v_add_u32 v8, 49152, v6
  v_add_u32 v9, 49152, v7
  v_mov_b32 v16, 0x3f803f80
  v_mov_b32 v17, 0x3f803f80
  v_mov_b32 v18, 0x3f803f80
  v_mov_b32 v19, 0x3f803f80
  v_lshrrev_b32 v22, 5, v1
  v_lshlrev_b32 v22, 10, v22
  v_lshlrev_b32 v25, 8, v25
  v_add_u32 v22, v22, v25
  v_add_u32 v22, v22, v24
  s_lshl_b32 s70, s24, 12
  v_add_u32 v22, s70, v22
  v_add_u32 v11, v22, v23
  v_add_u32 v12, v22, v26
  v_lshrrev_b32 v20, 2, v1
  v_and_b32 v20, 7, v20
  v_lshrrev_b32 v21, 2, v20
  v_lshlrev_b32 v21, 1, v21
  v_and_b32 v22, 3, v1
  v_xor_b32 v21, v21, v22
  v_lshlrev_b32 v21, 4, v21
  v_lshlrev_b32 v20, 10, v20
  v_add_u32 v20, v20, v21
  v_lshrrev_b32 v21, 5, v1
  v_lshlrev_b32 v21, 6, v21
  v_add_u32 v20, v20, v21
  s_lshl_b32 s72, s67, 7
  v_add_u32 v10, s72, v20
  v_and_b32 v252, 14, v1
  v_lshlrev_b32 v252, 4, v252
  v_and_b32 v20, 1, v1
  v_lshl_add_u32 v252, v20, 2, v252
  v_and_b32 v20, 15, v1
  v_lshlrev_b32 v21, 2, v20
  v_lshrrev_b32 v22, 4, v1
  v_lshlrev_b32 v23, 4, v22
  s_lshl_b32 s72, s25, 8
  s_add_u32 s72, s72, 155648
  s_lshl_b32 s73, s26, 7
  s_add_u32 s74, s72, s73
  s_sub_u32 s75, s72, s73
  v_add_u32 v240, s74, v21
  v_add_u32 v241, s75, v21
  v_add_u32 v243, s74, v23
  v_add_u32 v244, s75, v23
  v_lshrrev_b32 v24, 2, v20
  v_cmp_eq_u32 vcc, v24, v22
  v_mov_b32 v24, 158720
  s_mul_i32 s72, s24, 384
  s_add_u32 s72, s72, 156672
  v_cndmask_b32 v236, v24, v240, vcc
  v_add_u32 v237, s72, v21
  s_mul_i32 s72, s26, 384
  s_add_u32 s72, s72, 156672
  v_add_u32 v242, s72, v23
  v_add_u32 v245, s72, v21
  v_lshlrev_b32 v25, 4, v1
  s_mul_i32 s68, s24, 1280
  s_add_u32 s68, s68, 158720
  s_xor_b32 s69, s24, 2
  s_mul_i32 s69, s69, 1280
  s_add_u32 s69, s69, 158720
  s_lshl_b32 s72, s23, 1
  s_add_u32 s72, s72, 43
  s_mul_i32 s73, s23, 6
  s_sub_u32 s73, s73, 48
  s_cmp_lt_u32 s23, 8
  s_cselect_b32 s72, s72, s73
  s_cselect_b32 s75, 64, 43
  s_add_u32 s72, s72, s26
  s_lshl_b32 s74, s72, 10
  s_cmp_ge_u32 s72, s75
  s_cselect_b32 s74, 0x40000000, s74
  v_add_u32 v238, s74, v25
  s_add_u32 s72, s72, 2
  s_lshl_b32 s74, s72, 10
  s_cmp_ge_u32 s72, s75
  s_cselect_b32 s74, 0x40000000, s74
  v_add_u32 v239, s74, v25
  s_add_u32 s72, s72, 2
  s_lshl_b32 s74, s72, 10
  s_cmp_ge_u32 s72, s75
  s_cselect_b32 s74, 0x40000000, s74
  v_add_u32 v246, s74, v25
  s_add_u32 s72, s72, 2
  s_lshl_b32 s73, s22, 3
  s_lshl_b32 s74, s25, 2
  s_add_u32 s73, s73, s74
  s_lshl_b32 s74, s26, 1
  s_xor_b32 s75, s74, 0
  s_add_u32 s75, s75, s73
  s_mul_i32 s84, s75, 61440
  s_xor_b32 s75, s74, 1
  s_add_u32 s75, s75, s73
  s_mul_i32 s85, s75, 61440
  s_xor_b32 s75, s74, 2
  s_add_u32 s75, s75, s73
  s_mul_i32 s86, s75, 61440
  s_xor_b32 s75, s74, 3
  s_add_u32 s75, s75, s73
  s_mul_i32 s87, s75, 61440
  s_lshl_b32 s72, s23, 11
  s_lshl_b32 s73, s22, 7
  s_add_u32 s72, s72, s73
  s_add_u32 s72, s72, 8470528
  s_lshl_b32 s73, s22, 10
  s_lshl_b32 s74, s23, 7
  s_add_u32 s73, s73, s74
  s_add_u32 s73, s73, 8453120
  s_cmp_lt_u32 s23, 8
  s_cselect_b32 s0, s72, s73
  s_lshl_b32 s72, s23, 2
  s_lshl_b32 s73, s26, 1
  s_add_u32 s72, s72, s73
  s_add_u32 s72, s72, s25
  s_lshl_b32 s88, s72, 10
  s_add_u32 s88, s88, 8388608
  s_lshl_b32 s89, s72, 6
  s_add_u32 s89, s89, 8421376
  s_lshr_b32 s90, s66, 1
  s_lshl_b32 s90, s90, 10
  s_add_u32 s90, s90, 8454144
  s_lshl_b32 s91, s24, 12
  s_add_u32 s91, s91, 8470528
  s_mul_i32 s92, s66, 245760
  s_lshl_b32 s93, s66, 16
  s_lshl_b32 s72, s24, 14
  s_add_u32 s93, s93, s72
  s_lshl_b32 s72, s67, 7
  s_add_u32 s93, s93, s72
  s_and_b32 s72, s66, 3
  s_mul_i32 s72, s72, 3
  s_and_b32 s74, s67, 7
  s_mul_i32 s74, s74, 1
  s_add_u32 s72, s72, s74
  s_mul_i32 s74, s24, 11
  s_sub_u32 s73, s72, 11
  s_cmp_ge_u32 s72, 11
  s_cselect_b32 s72, s73, s72
  s_add_u32 s73, s72, s74
  s_lshl_b32 s5, s73, 10
  s_add_u32 s72, s72, 1
  s_sub_u32 s73, s72, 11
  s_cmp_ge_u32 s72, 11
  s_cselect_b32 s72, s73, s72
  s_add_u32 s73, s72, s74
  s_lshl_b32 s6, s73, 10
  s_add_u32 s72, s72, 1
  s_sub_u32 s73, s72, 11
  s_cmp_ge_u32 s72, 11
  s_cselect_b32 s72, s73, s72
  s_add_u32 s73, s72, s74
  s_lshl_b32 s7, s73, 10
  s_add_u32 s72, s72, 1
  s_sub_u32 s73, s72, 11
  s_cmp_ge_u32 s72, 11
  s_cselect_b32 s72, s73, s72
  s_add_u32 s73, s72, s74
  s_lshl_b32 s8, s73, 10
  s_add_u32 s72, s72, 1
  s_sub_u32 s73, s72, 11
  s_cmp_ge_u32 s72, 11
  s_cselect_b32 s72, s73, s72
  s_add_u32 s73, s72, s74
  s_lshl_b32 s9, s73, 10
  s_add_u32 s72, s72, 1
  s_sub_u32 s73, s72, 11
  s_cmp_ge_u32 s72, 11
  s_cselect_b32 s72, s73, s72
  s_add_u32 s73, s72, s74
  s_lshl_b32 s10, s73, 10
  s_add_u32 s72, s72, 1
  s_sub_u32 s73, s72, 11
  s_cmp_ge_u32 s72, 11
  s_cselect_b32 s72, s73, s72
  s_add_u32 s73, s72, s74
  s_lshl_b32 s11, s73, 10
  s_add_u32 s72, s72, 1
  s_sub_u32 s73, s72, 11
  s_cmp_ge_u32 s72, 11
  s_cselect_b32 s72, s73, s72
  s_add_u32 s73, s72, s74
  s_lshl_b32 s12, s73, 10
  s_add_u32 s72, s72, 1
  s_sub_u32 s73, s72, 11
  s_cmp_ge_u32 s72, 11
  s_cselect_b32 s72, s73, s72
  s_add_u32 s73, s72, s74
  s_lshl_b32 s13, s73, 10
  s_add_u32 s72, s72, 1
  s_sub_u32 s73, s72, 11
  s_cmp_ge_u32 s72, 11
  s_cselect_b32 s72, s73, s72
  s_add_u32 s73, s72, s74
  s_lshl_b32 s14, s73, 10
  s_add_u32 s72, s72, 1
  s_sub_u32 s73, s72, 11
  s_cmp_ge_u32 s72, 11
  s_cselect_b32 s72, s73, s72
  s_add_u32 s73, s72, s74
  s_lshl_b32 s15, s73, 10
  s_add_u32 s72, s72, 1
  s_add_u32 s72, s66, s67
  s_lshl_b32 s74, s24, 2
  s_and_b32 s73, s72, 3
  s_add_u32 s73, s73, s74
  s_lshl_b32 s16, s73, 10
  s_add_u32 s72, s72, 1
  s_and_b32 s73, s72, 3
  s_add_u32 s73, s73, s74
  s_lshl_b32 s17, s73, 10
  s_add_u32 s72, s72, 1
  s_and_b32 s73, s72, 3
  s_add_u32 s73, s73, s74
  s_lshl_b32 s18, s73, 10
  s_add_u32 s72, s72, 1
  s_and_b32 s73, s72, 3
  s_add_u32 s73, s73, s74
  s_lshl_b32 s19, s73, 10
  s_add_u32 s72, s72, 1
  s_lshl_b32 s72, s2, 2
  s_add_u32 s72, s72, s24
  s_mul_i32 s73, s72, 11
  v_min_u32 v14, 10, v1
  v_add_lshl_u32 v14, v14, s73, 7
  s_lshl_b32 s73, s72, 2
  v_and_b32 v15, 3, v1
  v_add_lshl_u32 v15, v15, s73, 7
  v_and_b32 v20, 3, v1
  v_mul_u32_u24 v20, 2211840, v20
  v_add_u32 v20, 60416, v20
  v_cmp_eq_u32 vcc, 4, v1
  v_mov_b32 v21, 8486912
  v_mov_b32 v22, 0
  v_cndmask_b32 v20, v20, v21, vcc
  v_mov_b32 v28, 0
  v_mov_b32 v29, 0
  v_mov_b32 v30, 0
  v_mov_b32 v31, 0
  v_cmp_gt_u32 vcc, 8, v1
  v_mov_b32 v32, 0x7ffffff0
  s_lshl_b32 s78, s22, 11
  s_add_u32 s78, s78, 8388608
  v_cndmask_b32 v32, v32, v25, vcc
  s_lshl_b32 s72, s22, 10
  s_add_u32 s79, s72, 8454144
  s_add_u32 s80, s72, 8470528
  s_lshl_b32 s81, s22, 7
  s_add_u32 s81, s81, 8421376
  s_lshl_b32 s82, s23, 2
  s_add_u32 s82, s82, s24
  s_add_u32 m0, s27, 16384
  s_add_u32 s4, s21, 0
  buffer_load_dwordx4 v2, s[28:31], s4 offen lds
  s_add_u32 m0, s27, 73728
  s_add_u32 s4, s58, s60
  buffer_load_dwordx4 v3, s[32:35], s4 offen lds
  s_add_u32 m0, s27, 81920
  s_add_u32 s4, s58, s61
  buffer_load_dwordx4 v3, s[32:35], s4 offen lds
  s_add_u32 m0, s27, 20480
  s_add_u32 s4, s21, 32768
  buffer_load_dwordx4 v2, s[28:31], s4 offen lds
  s_add_u32 m0, s27, 90112
  s_add_u32 s4, s58, s62
  buffer_load_dwordx4 v3, s[32:35], s4 offen lds
  s_add_u32 m0, s27, 24576
  s_add_u32 s4, s21, 65536
  buffer_load_dwordx4 v2, s[28:31], s4 offen lds
  s_add_u32 m0, s27, 77824
  s_add_u32 s4, s58, s63
  buffer_load_dwordx4 v3, s[32:35], s4 offen lds
  s_add_u32 m0, s27, 86016
  s_add_u32 s4, s58, s64
  buffer_load_dwordx4 v3, s[32:35], s4 offen lds
  s_add_u32 m0, s27, 28672
  s_add_u32 s4, s21, 98304
  buffer_load_dwordx4 v2, s[28:31], s4 offen lds
  s_add_u32 m0, s27, 94208
  s_add_u32 s4, s58, s65
  buffer_load_dwordx4 v3, s[32:35], s4 offen lds
  s_add_u32 s20, s20, 1
  s_and_b32 s20, s20, 7
  s_mul_i32 s58, s20, s59
  s_lshl_b32 s21, s20, 7
  s_add_u32 s21, s21, s57
  buffer_load_dword v255, v20, s[36:39], 0 offen
  buffer_load_dword v255, v22, s[48:51], 0 offen
  s_cmp_lg_u32 s82, 63
  s_cbranch_scc1 L_noz_1
  buffer_store_dwordx4 v[28:31], v25, s[36:39], s78 offen sc1
  buffer_store_dwordx4 v[28:31], v25, s[36:39], s78 offen offset:1024 sc1
  buffer_store_dwordx4 v[28:31], v25, s[36:39], s79 offen sc1
  buffer_store_dwordx4 v[28:31], v25, s[36:39], s80 offen sc1
  buffer_store_dwordx4 v[28:31], v32, s[36:39], s81 offen sc1
L_noz_1:
  s_waitcnt vmcnt(12)
  s_barrier
  ds_read_b128 v[20:23], v4 offset:0
  ds_read_b64_tr_b16 v[36:37], v6 offset:0
  ds_read_b64_tr_b16 v[38:39], v6 offset:256
  ds_read_b128 v[24:27], v4 offset:2048
  ds_read_b64_tr_b16 v[40:41], v7 offset:0
  ds_read_b64_tr_b16 v[42:43], v7 offset:256
  ds_read_b128 v[28:31], v5 offset:0
  ds_read_b128 v[32:35], v5 offset:2048
  ds_read_b64_tr_b16 v[44:45], v6 offset:8192
  ds_read_b64_tr_b16 v[46:47], v6 offset:8448
  ds_read_b64_tr_b16 v[48:49], v7 offset:8192
  ds_read_b64_tr_b16 v[50:51], v7 offset:8448
  ds_read_b64_tr_b16 v[52:53], v6 offset:16384
  ds_read_b64_tr_b16 v[54:55], v6 offset:16640
  ds_read_b64_tr_b16 v[56:57], v7 offset:16384
  ds_read_b64_tr_b16 v[58:59], v7 offset:16640
  s_cmp_ge_u32 s23, 8
  s_waitcnt lgkmcnt(0)
  s_cbranch_scc1 L_ffn
  v_mfma_f32_16x16x32_bf16 v[100:103], v[36:39], v[20:23], 0
  ds_read_b128 v[60:63], v4 offset:512
  s_add_u32 m0, s27, 32768
  v_mfma_f32_16x16x32_bf16 v[104:107], v[36:39], v[24:27], 0
  ds_read_b64_tr_b16 v[76:77], v6 offset:4096
  s_add_u32 s4, s21, 0
  v_mfma_f32_16x16x32_bf16 v[108:111], v[36:39], v[28:31], 0
  ds_read_b64_tr_b16 v[78:79], v6 offset:4352
  buffer_load_dwordx4 v2, s[28:31], s4 offen lds
  v_mfma_f32_16x16x32_bf16 v[112:115], v[36:39], v[32:35], 0
  ds_read_b128 v[64:67], v4 offset:2560
  s_add_u32 m0, s27, 98304
  v_mfma_f32_16x16x32_bf16 v[116:119], v[40:43], v[20:23], 0
  ds_read_b64_tr_b16 v[80:81], v7 offset:4096
  s_add_u32 s4, s58, s60
  v_mfma_f32_16x16x32_bf16 v[120:123], v[40:43], v[24:27], 0
  ds_read_b64_tr_b16 v[82:83], v7 offset:4352
  buffer_load_dwordx4 v3, s[32:35], s4 offen lds
  v_mfma_f32_16x16x32_bf16 v[124:127], v[40:43], v[28:31], 0
  ds_read_b128 v[68:71], v5 offset:512
  s_add_u32 m0, s27, 106496
  v_mfma_f32_16x16x32_bf16 v[128:131], v[40:43], v[32:35], 0
  ds_read_b128 v[72:75], v5 offset:2560
  v_mfma_f32_16x16x32_bf16 v[132:135], v[20:23], v[44:47], 0
  ds_read_b64_tr_b16 v[84:85], v6 offset:12288
  s_add_u32 s4, s58, s61
  v_mfma_f32_16x16x32_bf16 v[136:139], v[24:27], v[44:47], 0
  ds_read_b64_tr_b16 v[86:87], v6 offset:12544
  buffer_load_dwordx4 v3, s[32:35], s4 offen lds
  v_mfma_f32_16x16x32_bf16 v[140:143], v[28:31], v[44:47], 0
  ds_read_b64_tr_b16 v[88:89], v7 offset:12288
  s_add_u32 m0, s27, 36864
  v_mfma_f32_16x16x32_bf16 v[144:147], v[32:35], v[44:47], 0
  ds_read_b64_tr_b16 v[90:91], v7 offset:12544
  s_add_u32 s4, s21, 32768
  v_mfma_f32_16x16x32_bf16 v[148:151], v[20:23], v[48:51], 0
  ds_read_b64_tr_b16 v[92:93], v6 offset:20480
  buffer_load_dwordx4 v2, s[28:31], s4 offen lds
  v_mfma_f32_16x16x32_bf16 v[152:155], v[24:27], v[48:51], 0
  ds_read_b64_tr_b16 v[94:95], v6 offset:20736
  s_add_u32 m0, s27, 114688
  v_mfma_f32_16x16x32_bf16 v[156:159], v[28:31], v[48:51], 0
  ds_read_b64_tr_b16 v[96:97], v7 offset:20480
  s_add_u32 s4, s58, s62
  v_mfma_f32_16x16x32_bf16 v[160:163], v[32:35], v[48:51], 0
  ds_read_b64_tr_b16 v[98:99], v7 offset:20736
  v_mfma_f32_16x16x32_bf16 v[164:167], v[20:23], v[52:55], 0
  buffer_load_dwordx4 v3, s[32:35], s4 offen lds
  s_add_u32 m0, s27, 40960
  v_mfma_f32_16x16x32_bf16 v[168:171], v[24:27], v[52:55], 0
  s_add_u32 s4, s21, 65536
  buffer_load_dwordx4 v2, s[28:31], s4 offen lds
  v_mfma_f32_16x16x32_bf16 v[172:175], v[28:31], v[52:55], 0
  s_add_u32 m0, s27, 102400
  s_add_u32 s4, s58, s63
  v_mfma_f32_16x16x32_bf16 v[176:179], v[32:35], v[52:55], 0
  buffer_load_dwordx4 v3, s[32:35], s4 offen lds
  v_mfma_f32_16x16x32_bf16 v[180:183], v[20:23], v[56:59], 0
  s_add_u32 m0, s27, 110592
  s_add_u32 s4, s58, s64
  v_mfma_f32_16x16x32_bf16 v[184:187], v[24:27], v[56:59], 0
  buffer_load_dwordx4 v3, s[32:35], s4 offen lds
  s_add_u32 m0, s27, 45056
  v_mfma_f32_16x16x32_bf16 v[188:191], v[28:31], v[56:59], 0
  s_add_u32 s4, s21, 98304
  buffer_load_dwordx4 v2, s[28:31], s4 offen lds
  v_mfma_f32_16x16x32_bf16 v[192:195], v[32:35], v[56:59], 0
  s_add_u32 m0, s27, 118784
  v_mfma_f32_16x16x32_bf16 v[196:199], v[16:19], v[20:23], 0
  s_add_u32 s4, s58, s65
  buffer_load_dwordx4 v3, s[32:35], s4 offen lds
  v_mfma_f32_16x16x32_bf16 v[204:207], v[20:23], v[20:23], 0
  s_add_u32 s20, s20, 1
  s_and_b32 s20, s20, 7
  v_mfma_f32_16x16x32_bf16 v[200:203], v[16:19], v[24:27], 0
  s_mul_i32 s58, s20, s59
  s_lshl_b32 s21, s20, 7
  v_mfma_f32_16x16x32_bf16 v[208:211], v[24:27], v[24:27], 0
  s_add_u32 s21, s21, s57
  s_cmp_lg_u32 s25, 0
  s_cbranch_scc1 L_cs_2
  v_mfma_f32_16x16x32_bf16 v[212:215], v[16:19], v[36:39], 0
  v_mfma_f32_16x16x32_bf16 v[216:219], v[16:19], v[40:43], 0
  v_mfma_f32_16x16x32_bf16 v[220:223], v[16:19], v[44:47], 0
  v_mfma_f32_16x16x32_bf16 v[224:227], v[16:19], v[48:51], 0
  v_mfma_f32_16x16x32_bf16 v[228:231], v[16:19], v[52:55], 0
  v_mfma_f32_16x16x32_bf16 v[232:235], v[16:19], v[56:59], 0
L_cs_2:
  s_waitcnt vmcnt(12) lgkmcnt(0)
  s_barrier
  v_mfma_f32_16x16x32_bf16 v[100:103], v[76:79], v[60:63], v[100:103]
  ds_read_b128 v[20:23], v4 offset:16384
  s_add_u32 m0, s27, 0
  v_mfma_f32_16x16x32_bf16 v[104:107], v[76:79], v[64:67], v[104:107]
  ds_read_b64_tr_b16 v[36:37], v6 offset:24576
  v_mfma_f32_16x16x32_bf16 v[108:111], v[76:79], v[68:71], v[108:111]
  ds_read_b64_tr_b16 v[38:39], v6 offset:24832
  s_add_u32 s4, s21, 0
  v_mfma_f32_16x16x32_bf16 v[112:115], v[76:79], v[72:75], v[112:115]
  ds_read_b128 v[24:27], v4 offset:18432
  v_mfma_f32_16x16x32_bf16 v[116:119], v[80:83], v[60:63], v[116:119]
  ds_read_b64_tr_b16 v[40:41], v7 offset:24576
  v_mfma_f32_16x16x32_bf16 v[120:123], v[80:83], v[64:67], v[120:123]
  ds_read_b64_tr_b16 v[42:43], v7 offset:24832
  buffer_load_dwordx4 v2, s[28:31], s4 offen lds
  v_mfma_f32_16x16x32_bf16 v[124:127], v[80:83], v[68:71], v[124:127]
  ds_read_b128 v[28:31], v5 offset:16384
  v_mfma_f32_16x16x32_bf16 v[128:131], v[80:83], v[72:75], v[128:131]
  ds_read_b128 v[32:35], v5 offset:18432
  v_mfma_f32_16x16x32_bf16 v[132:135], v[60:63], v[84:87], v[132:135]
  ds_read_b64_tr_b16 v[44:45], v6 offset:32768
  s_add_u32 m0, s27, 49152
  v_mfma_f32_16x16x32_bf16 v[136:139], v[64:67], v[84:87], v[136:139]
  ds_read_b64_tr_b16 v[46:47], v6 offset:33024
  v_mfma_f32_16x16x32_bf16 v[140:143], v[68:71], v[84:87], v[140:143]
  ds_read_b64_tr_b16 v[48:49], v7 offset:32768
  s_add_u32 s4, s58, s60
  v_mfma_f32_16x16x32_bf16 v[144:147], v[72:75], v[84:87], v[144:147]
  ds_read_b64_tr_b16 v[50:51], v7 offset:33024
  v_mfma_f32_16x16x32_bf16 v[148:151], v[60:63], v[88:91], v[148:151]
  ds_read_b64_tr_b16 v[52:53], v6 offset:40960
  v_mfma_f32_16x16x32_bf16 v[152:155], v[64:67], v[88:91], v[152:155]
  ds_read_b64_tr_b16 v[54:55], v6 offset:41216
  buffer_load_dwordx4 v3, s[32:35], s4 offen lds
  v_mfma_f32_16x16x32_bf16 v[156:159], v[68:71], v[88:91], v[156:159]
  ds_read_b64_tr_b16 v[56:57], v7 offset:40960
  v_mfma_f32_16x16x32_bf16 v[160:163], v[72:75], v[88:91], v[160:163]
  ds_read_b64_tr_b16 v[58:59], v7 offset:41216
  v_mfma_f32_16x16x32_bf16 v[164:167], v[60:63], v[92:95], v[164:167]
  s_add_u32 m0, s27, 57344
  v_mfma_f32_16x16x32_bf16 v[168:171], v[64:67], v[92:95], v[168:171]
  s_add_u32 s4, s58, s61
  v_mfma_f32_16x16x32_bf16 v[172:175], v[68:71], v[92:95], v[172:175]
  buffer_load_dwordx4 v3, s[32:35], s4 offen lds
  v_mfma_f32_16x16x32_bf16 v[176:179], v[72:75], v[92:95], v[176:179]
  v_mfma_f32_16x16x32_bf16 v[180:183], v[60:63], v[96:99], v[180:183]
  s_add_u32 m0, s27, 4096
  v_mfma_f32_16x16x32_bf16 v[184:187], v[64:67], v[96:99], v[184:187]
  s_add_u32 s4, s21, 32768
  v_mfma_f32_16x16x32_bf16 v[188:191], v[68:71], v[96:99], v[188:191]
  buffer_load_dwordx4 v2, s[28:31], s4 offen lds
  v_mfma_f32_16x16x32_bf16 v[192:195], v[72:75], v[96:99], v[192:195]
  v_mfma_f32_16x16x32_bf16 v[196:199], v[16:19], v[60:63], v[196:199]
  s_add_u32 m0, s27, 65536
  v_mfma_f32_16x16x32_bf16 v[204:207], v[60:63], v[60:63], v[204:207]
  s_add_u32 s4, s58, s62
  v_mfma_f32_16x16x32_bf16 v[200:203], v[16:19], v[64:67], v[200:203]
  buffer_load_dwordx4 v3, s[32:35], s4 offen lds
  v_mfma_f32_16x16x32_bf16 v[208:211], v[64:67], v[64:67], v[208:211]
  s_cmp_lg_u32 s25, 1
  s_cbranch_scc1 L_cs_3
  v_mfma_f32_16x16x32_bf16 v[212:215], v[16:19], v[76:79], 0
  v_mfma_f32_16x16x32_bf16 v[216:219], v[16:19], v[80:83], 0
  v_mfma_f32_16x16x32_bf16 v[220:223], v[16:19], v[84:87], 0
  v_mfma_f32_16x16x32_bf16 v[224:227], v[16:19], v[88:91], 0
  v_mfma_f32_16x16x32_bf16 v[228:231], v[16:19], v[92:95], 0
  v_mfma_f32_16x16x32_bf16 v[232:235], v[16:19], v[96:99], 0
L_cs_3:
  s_waitcnt lgkmcnt(0)
  v_mfma_f32_16x16x32_bf16 v[100:103], v[36:39], v[20:23], v[100:103]
  ds_read_b128 v[60:63], v4 offset:16896
  s_add_u32 m0, s27, 8192
  v_mfma_f32_16x16x32_bf16 v[104:107], v[36:39], v[24:27], v[104:107]
  ds_read_b64_tr_b16 v[76:77], v6 offset:28672
  s_add_u32 s4, s21, 65536
  v_mfma_f32_16x16x32_bf16 v[108:111], v[36:39], v[28:31], v[108:111]
  ds_read_b64_tr_b16 v[78:79], v6 offset:28928
  v_mfma_f32_16x16x32_bf16 v[112:115], v[36:39], v[32:35], v[112:115]
  ds_read_b128 v[64:67], v4 offset:18944
  buffer_load_dwordx4 v2, s[28:31], s4 offen lds
  v_mfma_f32_16x16x32_bf16 v[116:119], v[40:43], v[20:23], v[116:119]
  ds_read_b64_tr_b16 v[80:81], v7 offset:28672
  v_mfma_f32_16x16x32_bf16 v[120:123], v[40:43], v[24:27], v[120:123]
  ds_read_b64_tr_b16 v[82:83], v7 offset:28928
  s_add_u32 m0, s27, 53248
  v_mfma_f32_16x16x32_bf16 v[124:127], v[40:43], v[28:31], v[124:127]
  ds_read_b128 v[68:71], v5 offset:16896
  v_mfma_f32_16x16x32_bf16 v[128:131], v[40:43], v[32:35], v[128:131]
  ds_read_b128 v[72:75], v5 offset:18944
  s_add_u32 s4, s58, s63
  v_mfma_f32_16x16x32_bf16 v[132:135], v[20:23], v[44:47], v[132:135]
  ds_read_b64_tr_b16 v[84:85], v6 offset:36864
  v_mfma_f32_16x16x32_bf16 v[136:139], v[24:27], v[44:47], v[136:139]
  ds_read_b64_tr_b16 v[86:87], v6 offset:37120
  buffer_load_dwordx4 v3, s[32:35], s4 offen lds
  v_mfma_f32_16x16x32_bf16 v[140:143], v[28:31], v[44:47], v[140:143]
  ds_read_b64_tr_b16 v[88:89], v7 offset:36864
  s_add_u32 m0, s27, 61440
  v_mfma_f32_16x16x32_bf16 v[144:147], v[32:35], v[44:47], v[144:147]
  ds_read_b64_tr_b16 v[90:91], v7 offset:37120
  v_mfma_f32_16x16x32_bf16 v[148:151], v[20:23], v[48:51], v[148:151]
  ds_read_b64_tr_b16 v[92:93], v6 offset:45056
  s_add_u32 s4, s58, s64
  v_mfma_f32_16x16x32_bf16 v[152:155], v[24:27], v[48:51], v[152:155]
  ds_read_b64_tr_b16 v[94:95], v6 offset:45312
  v_mfma_f32_16x16x32_bf16 v[156:159], v[28:31], v[48:51], v[156:159]
  ds_read_b64_tr_b16 v[96:97], v7 offset:45056
  buffer_load_dwordx4 v3, s[32:35], s4 offen lds
  v_mfma_f32_16x16x32_bf16 v[160:163], v[32:35], v[48:51], v[160:163]
  ds_read_b64_tr_b16 v[98:99], v7 offset:45312
  v_mfma_f32_16x16x32_bf16 v[164:167], v[20:23], v[52:55], v[164:167]
  s_add_u32 m0, s27, 12288
  v_mfma_f32_16x16x32_bf16 v[168:171], v[24:27], v[52:55], v[168:171]
  s_add_u32 s4, s21, 98304
  v_mfma_f32_16x16x32_bf16 v[172:175], v[28:31], v[52:55], v[172:175]
  buffer_load_dwordx4 v2, s[28:31], s4 offen lds
  s_add_u32 m0, s27, 69632
  v_mfma_f32_16x16x32_bf16 v[176:179], v[32:35], v[52:55], v[176:179]
  s_add_u32 s4, s58, s65
  v_mfma_f32_16x16x32_bf16 v[180:183], v[20:23], v[56:59], v[180:183]
  buffer_load_dwordx4 v3, s[32:35], s4 offen lds
  v_mfma_f32_16x16x32_bf16 v[184:187], v[24:27], v[56:59], v[184:187]
  s_add_u32 s20, s20, 1
  v_mfma_f32_16x16x32_bf16 v[188:191], v[28:31], v[56:59], v[188:191]
  s_and_b32 s20, s20, 7
  v_mfma_f32_16x16x32_bf16 v[192:195], v[32:35], v[56:59], v[192:195]
  s_mul_i32 s58, s20, s59
  v_mfma_f32_16x16x32_bf16 v[196:199], v[16:19], v[20:23], v[196:199]
  s_lshl_b32 s21, s20, 7
  v_mfma_f32_16x16x32_bf16 v[204:207], v[20:23], v[20:23], v[204:207]
  s_add_u32 s21, s21, s57
  v_mfma_f32_16x16x32_bf16 v[200:203], v[16:19], v[24:27], v[200:203]
  buffer_load_dword v255, v14, s[40:43], 0 offen
  v_mfma_f32_16x16x32_bf16 v[208:211], v[24:27], v[24:27], v[208:211]
  buffer_load_dword v255, v15, s[44:47], 0 offen
  s_cmp_lg_u32 s25, 0
  s_cbranch_scc1 L_cs_4
  v_mfma_f32_16x16x32_bf16 v[212:215], v[16:19], v[36:39], v[212:215]
  v_mfma_f32_16x16x32_bf16 v[216:219], v[16:19], v[40:43], v[216:219]
  v_mfma_f32_16x16x32_bf16 v[220:223], v[16:19], v[44:47], v[220:223]
  v_mfma_f32_16x16x32_bf16 v[224:227], v[16:19], v[48:51], v[224:227]
  v_mfma_f32_16x16x32_bf16 v[228:231], v[16:19], v[52:55], v[228:231]
  v_mfma_f32_16x16x32_bf16 v[232:235], v[16:19], v[56:59], v[232:235]
L_cs_4:
  s_waitcnt vmcnt(12) lgkmcnt(0)
  s_barrier
  v_mfma_f32_16x16x32_bf16 v[100:103], v[76:79], v[60:63], v[100:103]
  ds_read_b128 v[20:23], v4 offset:32768
  s_add_u32 m0, s27, 16384
  v_mfma_f32_16x16x32_bf16 v[104:107], v[76:79], v[64:67], v[104:107]
  ds_read_b64_tr_b16 v[36:37], v8 offset:0
  v_mfma_f32_16x16x32_bf16 v[108:111], v[76:79], v[68:71], v[108:111]
  ds_read_b64_tr_b16 v[38:39], v8 offset:256
  s_add_u32 s4, s21, 0
  v_mfma_f32_16x16x32_bf16 v[112:115], v[76:79], v[72:75], v[112:115]
  ds_read_b128 v[24:27], v4 offset:34816
  v_mfma_f32_16x16x32_bf16 v[116:119], v[80:83], v[60:63], v[116:119]
  ds_read_b64_tr_b16 v[40:41], v9 offset:0
  v_mfma_f32_16x16x32_bf16 v[120:123], v[80:83], v[64:67], v[120:123]
  ds_read_b64_tr_b16 v[42:43], v9 offset:256
  buffer_load_dwordx4 v2, s[28:31], s4 offen lds
  v_mfma_f32_16x16x32_bf16 v[124:127], v[80:83], v[68:71], v[124:127]
  ds_read_b128 v[28:31], v5 offset:32768
  v_mfma_f32_16x16x32_bf16 v[128:131], v[80:83], v[72:75], v[128:131]
  ds_read_b128 v[32:35], v5 offset:34816
  v_mfma_f32_16x16x32_bf16 v[132:135], v[60:63], v[84:87], v[132:135]
  ds_read_b64_tr_b16 v[44:45], v8 offset:8192
  s_add_u32 m0, s27, 73728
  v_mfma_f32_16x16x32_bf16 v[136:139], v[64:67], v[84:87], v[136:139]
  ds_read_b64_tr_b16 v[46:47], v8 offset:8448
  v_mfma_f32_16x16x32_bf16 v[140:143], v[68:71], v[84:87], v[140:143]
  ds_read_b64_tr_b16 v[48:49], v9 offset:8192
  s_add_u32 s4, s58, s60
  v_mfma_f32_16x16x32_bf16 v[144:147], v[72:75], v[84:87], v[144:147]
  ds_read_b64_tr_b16 v[50:51], v9 offset:8448
  v_mfma_f32_16x16x32_bf16 v[148:151], v[60:63], v[88:91], v[148:151]
  ds_read_b64_tr_b16 v[52:53], v8 offset:16384
  v_mfma_f32_16x16x32_bf16 v[152:155], v[64:67], v[88:91], v[152:155]
  ds_read_b64_tr_b16 v[54:55], v8 offset:16640
  buffer_load_dwordx4 v3, s[32:35], s4 offen lds
  v_mfma_f32_16x16x32_bf16 v[156:159], v[68:71], v[88:91], v[156:159]
  ds_read_b64_tr_b16 v[56:57], v9 offset:16384
  v_mfma_f32_16x16x32_bf16 v[160:163], v[72:75], v[88:91], v[160:163]
  ds_read_b64_tr_b16 v[58:59], v9 offset:16640
  v_mfma_f32_16x16x32_bf16 v[164:167], v[60:63], v[92:95], v[164:167]
  s_add_u32 m0, s27, 81920
  v_mfma_f32_16x16x32_bf16 v[168:171], v[64:67], v[92:95], v[168:171]
  s_add_u32 s4, s58, s61
  v_mfma_f32_16x16x32_bf16 v[172:175], v[68:71], v[92:95], v[172:175]
  buffer_load_dwordx4 v3, s[32:35], s4 offen lds
  v_mfma_f32_16x16x32_bf16 v[176:179], v[72:75], v[92:95], v[176:179]
  v_mfma_f32_16x16x32_bf16 v[180:183], v[60:63], v[96:99], v[180:183]
  s_add_u32 m0, s27, 20480
  v_mfma_f32_16x16x32_bf16 v[184:187], v[64:67], v[96:99], v[184:187]
  s_add_u32 s4, s21, 32768
  v_mfma_f32_16x16x32_bf16 v[188:191], v[68:71], v[96:99], v[188:191]
  buffer_load_dwordx4 v2, s[28:31], s4 offen lds
  v_mfma_f32_16x16x32_bf16 v[192:195], v[72:75], v[96:99], v[192:195]
  v_mfma_f32_16x16x32_bf16 v[196:199], v[16:19], v[60:63], v[196:199]
  s_add_u32 m0, s27, 90112
  v_mfma_f32_16x16x32_bf16 v[204:207], v[60:63], v[60:63], v[204:207]
  s_add_u32 s4, s58, s62
  v_mfma_f32_16x16x32_bf16 v[200:203], v[16:19], v[64:67], v[200:203]
  buffer_load_dwordx4 v3, s[32:35], s4 offen lds
  v_mfma_f32_16x16x32_bf16 v[208:211], v[64:67], v[64:67], v[208:211]
  s_cmp_lg_u32 s25, 1
  s_cbranch_scc1 L_cs_5
  v_mfma_f32_16x16x32_bf16 v[212:215], v[16:19], v[76:79], v[212:215]
  v_mfma_f32_16x16x32_bf16 v[216:219], v[16:19], v[80:83], v[216:219]
  v_mfma_f32_16x16x32_bf16 v[220:223], v[16:19], v[84:87], v[220:223]
  v_mfma_f32_16x16x32_bf16 v[224:227], v[16:19], v[88:91], v[224:227]
  v_mfma_f32_16x16x32_bf16 v[228:231], v[16:19], v[92:95], v[228:231]
  v_mfma_f32_16x16x32_bf16 v[232:235], v[16:19], v[96:99], v[232:235]
L_cs_5:
  s_waitcnt lgkmcnt(0)
  v_mfma_f32_16x16x32_bf16 v[100:103], v[36:39], v[20:23], v[100:103]
  ds_read_b128 v[60:63], v4 offset:33280
  s_add_u32 m0, s27, 24576
  v_mfma_f32_16x16x32_bf16 v[104:107], v[36:39], v[24:27], v[104:107]
  ds_read_b64_tr_b16 v[76:77], v8 offset:4096
  v_mfma_f32_16x16x32_bf16 v[108:111], v[36:39], v[28:31], v[108:111]
  ds_read_b64_tr_b16 v[78:79], v8 offset:4352
  s_add_u32 s4, s21, 65536
  v_mfma_f32_16x16x32_bf16 v[112:115], v[36:39], v[32:35], v[112:115]
  ds_read_b128 v[64:67], v4 offset:35328
  v_mfma_f32_16x16x32_bf16 v[116:119], v[40:43], v[20:23], v[116:119]
  ds_read_b64_tr_b16 v[80:81], v9 offset:4096
  buffer_load_dwordx4 v2, s[28:31], s4 offen lds
  v_mfma_f32_16x16x32_bf16 v[120:123], v[40:43], v[24:27], v[120:123]
  ds_read_b64_tr_b16 v[82:83], v9 offset:4352
  v_mfma_f32_16x16x32_bf16 v[124:127], v[40:43], v[28:31], v[124:127]
  ds_read_b128 v[68:71], v5 offset:33280
  s_add_u32 m0, s27, 77824
  v_mfma_f32_16x16x32_bf16 v[128:131], v[40:43], v[32:35], v[128:131]
  ds_read_b128 v[72:75], v5 offset:35328
  v_mfma_f32_16x16x32_bf16 v[132:135], v[20:23], v[44:47], v[132:135]
  ds_read_b64_tr_b16 v[84:85], v8 offset:12288
  s_add_u32 s4, s58, s63
  v_mfma_f32_16x16x32_bf16 v[136:139], v[24:27], v[44:47], v[136:139]
  ds_read_b64_tr_b16 v[86:87], v8 offset:12544
  v_mfma_f32_16x16x32_bf16 v[140:143], v[28:31], v[44:47], v[140:143]
  ds_read_b64_tr_b16 v[88:89], v9 offset:12288
  buffer_load_dwordx4 v3, s[32:35], s4 offen lds
  v_mfma_f32_16x16x32_bf16 v[144:147], v[32:35], v[44:47], v[144:147]
  ds_read_b64_tr_b16 v[90:91], v9 offset:12544
  v_mfma_f32_16x16x32_bf16 v[148:151], v[20:23], v[48:51], v[148:151]
  ds_read_b64_tr_b16 v[92:93], v8 offset:20480
  s_add_u32 m0, s27, 86016
  v_mfma_f32_16x16x32_bf16 v[152:155], v[24:27], v[48:51], v[152:155]
  ds_read_b64_tr_b16 v[94:95], v8 offset:20736
  v_mfma_f32_16x16x32_bf16 v[156:159], v[28:31], v[48:51], v[156:159]
  ds_read_b64_tr_b16 v[96:97], v9 offset:20480
  s_add_u32 s4, s58, s64
  v_mfma_f32_16x16x32_bf16 v[160:163], v[32:35], v[48:51], v[160:163]
  ds_read_b64_tr_b16 v[98:99], v9 offset:20736
  v_mfma_f32_16x16x32_bf16 v[164:167], v[20:23], v[52:55], v[164:167]
  buffer_load_dwordx4 v3, s[32:35], s4 offen lds
  v_mfma_f32_16x16x32_bf16 v[168:171], v[24:27], v[52:55], v[168:171]
  s_add_u32 m0, s27, 28672
  v_mfma_f32_16x16x32_bf16 v[172:175], v[28:31], v[52:55], v[172:175]
  s_add_u32 s4, s21, 98304
  v_mfma_f32_16x16x32_bf16 v[176:179], v[32:35], v[52:55], v[176:179]
  buffer_load_dwordx4 v2, s[28:31], s4 offen lds
  v_mfma_f32_16x16x32_bf16 v[180:183], v[20:23], v[56:59], v[180:183]
  s_add_u32 m0, s27, 94208
  v_mfma_f32_16x16x32_bf16 v[184:187], v[24:27], v[56:59], v[184:187]
  s_add_u32 s4, s58, s65
  v_mfma_f32_16x16x32_bf16 v[188:191], v[28:31], v[56:59], v[188:191]
  buffer_load_dwordx4 v3, s[32:35], s4 offen lds
  v_mfma_f32_16x16x32_bf16 v[192:195], v[32:35], v[56:59], v[192:195]
  s_add_u32 s20, s20, 1
  v_mfma_f32_16x16x32_bf16 v[196:199], v[16:19], v[20:23], v[196:199]
  s_and_b32 s20, s20, 7
  v_mfma_f32_16x16x32_bf16 v[204:207], v[20:23], v[20:23], v[204:207]
  s_mul_i32 s58, s20, s59
  v_mfma_f32_16x16x32_bf16 v[200:203], v[16:19], v[24:27], v[200:203]
  s_lshl_b32 s21, s20, 7
  v_mfma_f32_16x16x32_bf16 v[208:211], v[24:27], v[24:27], v[208:211]
  s_add_u32 s21, s21, s57
  s_cmp_lg_u32 s25, 0
  s_cbranch_scc1 L_cs_6
  v_mfma_f32_16x16x32_bf16 v[212:215], v[16:19], v[36:39], v[212:215]
  v_mfma_f32_16x16x32_bf16 v[216:219], v[16:19], v[40:43], v[216:219]
  v_mfma_f32_16x16x32_bf16 v[220:223], v[16:19], v[44:47], v[220:223]
  v_mfma_f32_16x16x32_bf16 v[224:227], v[16:19], v[48:51], v[224:227]
  v_mfma_f32_16x16x32_bf16 v[228:231], v[16:19], v[52:55], v[228:231]
  v_mfma_f32_16x16x32_bf16 v[232:235], v[16:19], v[56:59], v[232:235]
L_cs_6:
  s_waitcnt vmcnt(12) lgkmcnt(0)
  s_barrier
  v_mfma_f32_16x16x32_bf16 v[100:103], v[76:79], v[60:63], v[100:103]
  ds_read_b128 v[20:23], v4 offset:0
  s_add_u32 m0, s27, 32768
  v_mfma_f32_16x16x32_bf16 v[104:107], v[76:79], v[64:67], v[104:107]
  ds_read_b64_tr_b16 v[36:37], v6 offset:0
  v_mfma_f32_16x16x32_bf16 v[108:111], v[76:79], v[68:71], v[108:111]
  ds_read_b64_tr_b16 v[38:39], v6 offset:256
  s_add_u32 s4, s21, 0
  v_mfma_f32_16x16x32_bf16 v[112:115], v[76:79], v[72:75], v[112:115]
  ds_read_b128 v[24:27], v4 offset:2048
  v_mfma_f32_16x16x32_bf16 v[116:119], v[80:83], v[60:63], v[116:119]
  ds_read_b64_tr_b16 v[40:41], v7 offset:0
  v_mfma_f32_16x16x32_bf16 v[120:123], v[80:83], v[64:67], v[120:123]
  ds_read_b64_tr_b16 v[42:43], v7 offset:256
  buffer_load_dwordx4 v2, s[28:31], s4 offen lds
  v_mfma_f32_16x16x32_bf16 v[124:127], v[80:83], v[68:71], v[124:127]
  ds_read_b128 v[28:31], v5 offset:0
  v_mfma_f32_16x16x32_bf16 v[128:131], v[80:83], v[72:75], v[128:131]
  ds_read_b128 v[32:35], v5 offset:2048
  v_mfma_f32_16x16x32_bf16 v[132:135], v[60:63], v[84:87], v[132:135]
  ds_read_b64_tr_b16 v[44:45], v6 offset:8192
  s_add_u32 m0, s27, 98304
  v_mfma_f32_16x16x32_bf16 v[136:139], v[64:67], v[84:87], v[136:139]
  ds_read_b64_tr_b16 v[46:47], v6 offset:8448
  v_mfma_f32_16x16x32_bf16 v[140:143], v[68:71], v[84:87], v[140:143]
  ds_read_b64_tr_b16 v[48:49], v7 offset:8192
  s_add_u32 s4, s58, s60
  v_mfma_f32_16x16x32_bf16 v[144:147], v[72:75], v[84:87], v[144:147]
  ds_read_b64_tr_b16 v[50:51], v7 offset:8448
  v_mfma_f32_16x16x32_bf16 v[148:151], v[60:63], v[88:91], v[148:151]
  ds_read_b64_tr_b16 v[52:53], v6 offset:16384
  v_mfma_f32_16x16x32_bf16 v[152:155], v[64:67], v[88:91], v[152:155]
  ds_read_b64_tr_b16 v[54:55], v6 offset:16640
  buffer_load_dwordx4 v3, s[32:35], s4 offen lds
  v_mfma_f32_16x16x32_bf16 v[156:159], v[68:71], v[88:91], v[156:159]
  ds_read_b64_tr_b16 v[56:57], v7 offset:16384
  v_mfma_f32_16x16x32_bf16 v[160:163], v[72:75], v[88:91], v[160:163]
  ds_read_b64_tr_b16 v[58:59], v7 offset:16640
  v_mfma_f32_16x16x32_bf16 v[164:167], v[60:63], v[92:95], v[164:167]
  s_add_u32 m0, s27, 106496
  v_mfma_f32_16x16x32_bf16 v[168:171], v[64:67], v[92:95], v[168:171]
  s_add_u32 s4, s58, s61
  v_mfma_f32_16x16x32_bf16 v[172:175], v[68:71], v[92:95], v[172:175]
  buffer_load_dwordx4 v3, s[32:35], s4 offen lds
  v_mfma_f32_16x16x32_bf16 v[176:179], v[72:75], v[92:95], v[176:179]
  v_mfma_f32_16x16x32_bf16 v[180:183], v[60:63], v[96:99], v[180:183]
  s_add_u32 m0, s27, 36864
  v_mfma_f32_16x16x32_bf16 v[184:187], v[64:67], v[96:99], v[184:187]
  s_add_u32 s4, s21, 32768
  v_mfma_f32_16x16x32_bf16 v[188:191], v[68:71], v[96:99], v[188:191]
  buffer_load_dwordx4 v2, s[28:31], s4 offen lds
  v_mfma_f32_16x16x32_bf16 v[192:195], v[72:75], v[96:99], v[192:195]
  v_mfma_f32_16x16x32_bf16 v[196:199], v[16:19], v[60:63], v[196:199]
  s_add_u32 m0, s27, 114688
  v_mfma_f32_16x16x32_bf16 v[204:207], v[60:63], v[60:63], v[204:207]
  s_add_u32 s4, s58, s62
  v_mfma_f32_16x16x32_bf16 v[200:203], v[16:19], v[64:67], v[200:203]
  buffer_load_dwordx4 v3, s[32:35], s4 offen lds
  v_mfma_f32_16x16x32_bf16 v[208:211], v[64:67], v[64:67], v[208:211]
  s_cmp_lg_u32 s25, 1
  s_cbranch_scc1 L_cs_7
  v_mfma_f32_16x16x32_bf16 v[212:215], v[16:19], v[76:79], v[212:215]
  v_mfma_f32_16x16x32_bf16 v[216:219], v[16:19], v[80:83], v[216:219]
  v_mfma_f32_16x16x32_bf16 v[220:223], v[16:19], v[84:87], v[220:223]
  v_mfma_f32_16x16x32_bf16 v[224:227], v[16:19], v[88:91], v[224:227]
  v_mfma_f32_16x16x32_bf16 v[228:231], v[16:19], v[92:95], v[228:231]
  v_mfma_f32_16x16x32_bf16 v[232:235], v[16:19], v[96:99], v[232:235]
L_cs_7:
  s_waitcnt lgkmcnt(0)
  v_mfma_f32_16x16x32_bf16 v[100:103], v[36:39], v[20:23], v[100:103]
  ds_read_b128 v[60:63], v4 offset:512
  s_add_u32 m0, s27, 40960
  v_mfma_f32_16x16x32_bf16 v[104:107], v[36:39], v[24:27], v[104:107]
  ds_read_b64_tr_b16 v[76:77], v6 offset:4096
  s_add_u32 s4, s21, 65536
  v_mfma_f32_16x16x32_bf16 v[108:111], v[36:39], v[28:31], v[108:111]
  ds_read_b64_tr_b16 v[78:79], v6 offset:4352
  buffer_load_dwordx4 v2, s[28:31], s4 offen lds
  v_mfma_f32_16x16x32_bf16 v[112:115], v[36:39], v[32:35], v[112:115]
  ds_read_b128 v[64:67], v4 offset:2560
  s_add_u32 m0, s27, 102400
  v_mfma_f32_16x16x32_bf16 v[116:119], v[40:43], v[20:23], v[116:119]
  ds_read_b64_tr_b16 v[80:81], v7 offset:4096
  s_add_u32 s4, s58, s63
  v_mfma_f32_16x16x32_bf16 v[120:123], v[40:43], v[24:27], v[120:123]
  ds_read_b64_tr_b16 v[82:83], v7 offset:4352
  v_mfma_f32_16x16x32_bf16 v[124:127], v[40:43], v[28:31], v[124:127]
  ds_read_b128 v[68:71], v5 offset:512
  buffer_load_dwordx4 v3, s[32:35], s4 offen lds
  v_mfma_f32_16x16x32_bf16 v[128:131], v[40:43], v[32:35], v[128:131]
  ds_read_b128 v[72:75], v5 offset:2560
  s_add_u32 m0, s27, 110592
  v_mfma_f32_16x16x32_bf16 v[132:135], v[20:23], v[44:47], v[132:135]
  ds_read_b64_tr_b16 v[84:85], v6 offset:12288
  s_add_u32 s4, s58, s64
  v_mfma_f32_16x16x32_bf16 v[136:139], v[24:27], v[44:47], v[136:139]
  ds_read_b64_tr_b16 v[86:87], v6 offset:12544
  buffer_load_dwordx4 v3, s[32:35], s4 offen lds
  v_mfma_f32_16x16x32_bf16 v[140:143], v[28:31], v[44:47], v[140:143]
  ds_read_b64_tr_b16 v[88:89], v7 offset:12288
  s_add_u32 m0, s27, 45056
  v_mfma_f32_16x16x32_bf16 v[144:147], v[32:35], v[44:47], v[144:147]
  ds_read_b64_tr_b16 v[90:91], v7 offset:12544
  v_mfma_f32_16x16x32_bf16 v[148:151], v[20:23], v[48:51], v[148:151]
  ds_read_b64_tr_b16 v[92:93], v6 offset:20480
  s_add_u32 s4, s21, 98304
  v_mfma_f32_16x16x32_bf16 v[152:155], v[24:27], v[48:51], v[152:155]
  ds_read_b64_tr_b16 v[94:95], v6 offset:20736
  buffer_load_dwordx4 v2, s[28:31], s4 offen lds
  v_mfma_f32_16x16x32_bf16 v[156:159], v[28:31], v[48:51], v[156:159]
  ds_read_b64_tr_b16 v[96:97], v7 offset:20480
  s_add_u32 m0, s27, 118784
  v_mfma_f32_16x16x32_bf16 v[160:163], v[32:35], v[48:51], v[160:163]
  ds_read_b64_tr_b16 v[98:99], v7 offset:20736
  s_add_u32 s4, s58, s65
  v_mfma_f32_16x16x32_bf16 v[164:167], v[20:23], v[52:55], v[164:167]
  buffer_load_dwordx4 v3, s[32:35], s4 offen lds
  v_mfma_f32_16x16x32_bf16 v[168:171], v[24:27], v[52:55], v[168:171]
  s_add_u32 s20, s20, 1
  s_and_b32 s20, s20, 7
  v_mfma_f32_16x16x32_bf16 v[172:175], v[28:31], v[52:55], v[172:175]
  s_mul_i32 s58, s20, s59
  s_lshl_b32 s21, s20, 7
  v_mfma_f32_16x16x32_bf16 v[176:179], v[32:35], v[52:55], v[176:179]
  s_add_u32 s21, s21, s57
  v_mfma_f32_16x16x32_bf16 v[180:183], v[20:23], v[56:59], v[180:183]
  s_lshl_b32 s3, s5, 5
  s_add_u32 m0, s70, 122880
  v_mfma_f32_16x16x32_bf16 v[184:187], v[24:27], v[56:59], v[184:187]
  s_add_u32 s4, s3, 0
  buffer_load_dwordx4 v10, s[40:43], s4 offen lds
  v_mfma_f32_16x16x32_bf16 v[188:191], v[28:31], v[56:59], v[188:191]
  s_add_u32 m0, s70, 123904
  v_mfma_f32_16x16x32_bf16 v[192:195], v[32:35], v[56:59], v[192:195]
  s_add_u32 s4, s3, 8192
  buffer_load_dwordx4 v10, s[40:43], s4 offen lds
  v_mfma_f32_16x16x32_bf16 v[196:199], v[16:19], v[20:23], v[196:199]
  s_add_u32 m0, s70, 124928
  s_add_u32 s4, s3, 16384
  v_mfma_f32_16x16x32_bf16 v[204:207], v[20:23], v[20:23], v[204:207]
  buffer_load_dwordx4 v10, s[40:43], s4 offen lds
  v_mfma_f32_16x16x32_bf16 v[200:203], v[16:19], v[24:27], v[200:203]
  s_add_u32 m0, s70, 125952
  s_add_u32 s4, s3, 24576
  v_mfma_f32_16x16x32_bf16 v[208:211], v[24:27], v[24:27], v[208:211]
  buffer_load_dwordx4 v10, s[40:43], s4 offen lds
  s_cmp_lg_u32 s25, 0
  s_cbranch_scc1 L_cs_8
  v_mfma_f32_16x16x32_bf16 v[212:215], v[16:19], v[36:39], v[212:215]
  v_mfma_f32_16x16x32_bf16 v[216:219], v[16:19], v[40:43], v[216:219]
  v_mfma_f32_16x16x32_bf16 v[220:223], v[16:19], v[44:47], v[220:223]
  v_mfma_f32_16x16x32_bf16 v[224:227], v[16:19], v[48:51], v[224:227]
  v_mfma_f32_16x16x32_bf16 v[228:231], v[16:19], v[52:55], v[228:231]
  v_mfma_f32_16x16x32_bf16 v[232:235], v[16:19], v[56:59], v[232:235]
L_cs_8:
  s_waitcnt vmcnt(14) lgkmcnt(0)
  s_barrier
  v_mfma_f32_16x16x32_bf16 v[100:103], v[76:79], v[60:63], v[100:103]
  ds_read_b128 v[20:23], v4 offset:16384
  s_add_u32 m0, s27, 0
  v_mfma_f32_16x16x32_bf16 v[104:107], v[76:79], v[64:67], v[104:107]
  ds_read_b64_tr_b16 v[36:37], v6 offset:24576
  v_mfma_f32_16x16x32_bf16 v[108:111], v[76:79], v[68:71], v[108:111]
  ds_read_b64_tr_b16 v[38:39], v6 offset:24832
  s_add_u32 s4, s21, 0
  v_mfma_f32_16x16x32_bf16 v[112:115], v[76:79], v[72:75], v[112:115]
  ds_read_b128 v[24:27], v4 offset:18432
  v_mfma_f32_16x16x32_bf16 v[116:119], v[80:83], v[60:63], v[116:119]
  ds_read_b64_tr_b16 v[40:41], v7 offset:24576
  v_mfma_f32_16x16x32_bf16 v[120:123], v[80:83], v[64:67], v[120:123]
  ds_read_b64_tr_b16 v[42:43], v7 offset:24832
  buffer_load_dwordx4 v2, s[28:31], s4 offen lds
  v_mfma_f32_16x16x32_bf16 v[124:127], v[80:83], v[68:71], v[124:127]
  ds_read_b128 v[28:31], v5 offset:16384
  v_mfma_f32_16x16x32_bf16 v[128:131], v[80:83], v[72:75], v[128:131]
  ds_read_b128 v[32:35], v5 offset:18432
  v_mfma_f32_16x16x32_bf16 v[132:135], v[60:63], v[84:87], v[132:135]
  ds_read_b64_tr_b16 v[44:45], v6 offset:32768
  s_add_u32 m0, s27, 49152
  v_mfma_f32_16x16x32_bf16 v[136:139], v[64:67], v[84:87], v[136:139]
  ds_read_b64_tr_b16 v[46:47], v6 offset:33024
  v_mfma_f32_16x16x32_bf16 v[140:143], v[68:71], v[84:87], v[140:143]
  ds_read_b64_tr_b16 v[48:49], v7 offset:32768
  s_add_u32 s4, s58, s60
  v_mfma_f32_16x16x32_bf16 v[144:147], v[72:75], v[84:87], v[144:147]
  ds_read_b64_tr_b16 v[50:51], v7 offset:33024
  v_mfma_f32_16x16x32_bf16 v[148:151], v[60:63], v[88:91], v[148:151]
  ds_read_b64_tr_b16 v[52:53], v6 offset:40960
  v_mfma_f32_16x16x32_bf16 v[152:155], v[64:67], v[88:91], v[152:155]
  ds_read_b64_tr_b16 v[54:55], v6 offset:41216
  buffer_load_dwordx4 v3, s[32:35], s4 offen lds
  v_mfma_f32_16x16x32_bf16 v[156:159], v[68:71], v[88:91], v[156:159]
  ds_read_b64_tr_b16 v[56:57], v7 offset:40960
  v_mfma_f32_16x16x32_bf16 v[160:163], v[72:75], v[88:91], v[160:163]
  ds_read_b64_tr_b16 v[58:59], v7 offset:41216
  v_mfma_f32_16x16x32_bf16 v[164:167], v[60:63], v[92:95], v[164:167]
  s_add_u32 m0, s27, 57344
  v_mfma_f32_16x16x32_bf16 v[168:171], v[64:67], v[92:95], v[168:171]
  s_add_u32 s4, s58, s61
  v_mfma_f32_16x16x32_bf16 v[172:175], v[68:71], v[92:95], v[172:175]
  buffer_load_dwordx4 v3, s[32:35], s4 offen lds
  v_mfma_f32_16x16x32_bf16 v[176:179], v[72:75], v[92:95], v[176:179]
  v_mfma_f32_16x16x32_bf16 v[180:183], v[60:63], v[96:99], v[180:183]
  s_add_u32 m0, s27, 4096
  v_mfma_f32_16x16x32_bf16 v[184:187], v[64:67], v[96:99], v[184:187]
  s_add_u32 s4, s21, 32768
  v_mfma_f32_16x16x32_bf16 v[188:191], v[68:71], v[96:99], v[188:191]
  buffer_load_dwordx4 v2, s[28:31], s4 offen lds
  v_mfma_f32_16x16x32_bf16 v[192:195], v[72:75], v[96:99], v[192:195]
  v_mfma_f32_16x16x32_bf16 v[196:199], v[16:19], v[60:63], v[196:199]
  s_add_u32 m0, s27, 65536
  v_mfma_f32_16x16x32_bf16 v[204:207], v[60:63], v[60:63], v[204:207]
  s_add_u32 s4, s58, s62
  v_mfma_f32_16x16x32_bf16 v[200:203], v[16:19], v[64:67], v[200:203]
  buffer_load_dwordx4 v3, s[32:35], s4 offen lds
  v_mfma_f32_16x16x32_bf16 v[208:211], v[64:67], v[64:67], v[208:211]
  s_cmp_lg_u32 s25, 1
  s_cbranch_scc1 L_cs_9
  v_mfma_f32_16x16x32_bf16 v[212:215], v[16:19], v[76:79], v[212:215]
  v_mfma_f32_16x16x32_bf16 v[216:219], v[16:19], v[80:83], v[216:219]
  v_mfma_f32_16x16x32_bf16 v[220:223], v[16:19], v[84:87], v[220:223]
  v_mfma_f32_16x16x32_bf16 v[224:227], v[16:19], v[88:91], v[224:227]
  v_mfma_f32_16x16x32_bf16 v[228:231], v[16:19], v[92:95], v[228:231]
  v_mfma_f32_16x16x32_bf16 v[232:235], v[16:19], v[96:99], v[232:235]
L_cs_9:
  s_waitcnt lgkmcnt(0)
  v_mfma_f32_16x16x32_bf16 v[100:103], v[36:39], v[20:23], v[100:103]
  ds_read_b128 v[60:63], v4 offset:16896
  s_add_u32 m0, s27, 8192
  v_mfma_f32_16x16x32_bf16 v[104:107], v[36:39], v[24:27], v[104:107]
  ds_read_b64_tr_b16 v[76:77], v6 offset:28672
  s_add_u32 s4, s21, 65536
  v_mfma_f32_16x16x32_bf16 v[108:111], v[36:39], v[28:31], v[108:111]
  ds_read_b64_tr_b16 v[78:79], v6 offset:28928
  buffer_load_dwordx4 v2, s[28:31], s4 offen lds
  v_mfma_f32_16x16x32_bf16 v[112:115], v[36:39], v[32:35], v[112:115]
  ds_read_b128 v[64:67], v4 offset:18944
  s_add_u32 m0, s27, 53248
  v_mfma_f32_16x16x32_bf16 v[116:119], v[40:43], v[20:23], v[116:119]
  ds_read_b64_tr_b16 v[80:81], v7 offset:28672
  s_add_u32 s4, s58, s63
  v_mfma_f32_16x16x32_bf16 v[120:123], v[40:43], v[24:27], v[120:123]
  ds_read_b64_tr_b16 v[82:83], v7 offset:28928
  v_mfma_f32_16x16x32_bf16 v[124:127], v[40:43], v[28:31], v[124:127]
  ds_read_b128 v[68:71], v5 offset:16896
  buffer_load_dwordx4 v3, s[32:35], s4 offen lds
  v_mfma_f32_16x16x32_bf16 v[128:131], v[40:43], v[32:35], v[128:131]
  ds_read_b128 v[72:75], v5 offset:18944
  s_add_u32 m0, s27, 61440
  v_mfma_f32_16x16x32_bf16 v[132:135], v[20:23], v[44:47], v[132:135]
  ds_read_b64_tr_b16 v[84:85], v6 offset:36864
  s_add_u32 s4, s58, s64
  v_mfma_f32_16x16x32_bf16 v[136:139], v[24:27], v[44:47], v[136:139]
  ds_read_b64_tr_b16 v[86:87], v6 offset:37120
  buffer_load_dwordx4 v3, s[32:35], s4 offen lds
  v_mfma_f32_16x16x32_bf16 v[140:143], v[28:31], v[44:47], v[140:143]
  ds_read_b64_tr_b16 v[88:89], v7 offset:36864
  s_add_u32 m0, s27, 12288
  v_mfma_f32_16x16x32_bf16 v[144:147], v[32:35], v[44:47], v[144:147]
  ds_read_b64_tr_b16 v[90:91], v7 offset:37120
  v_mfma_f32_16x16x32_bf16 v[148:151], v[20:23], v[48:51], v[148:151]
  ds_read_b64_tr_b16 v[92:93], v6 offset:45056
  s_add_u32 s4, s21, 98304
  v_mfma_f32_16x16x32_bf16 v[152:155], v[24:27], v[48:51], v[152:155]
  ds_read_b64_tr_b16 v[94:95], v6 offset:45312
  buffer_load_dwordx4 v2, s[28:31], s4 offen lds
  v_mfma_f32_16x16x32_bf16 v[156:159], v[28:31], v[48:51], v[156:159]
  ds_read_b64_tr_b16 v[96:97], v7 offset:45056
  s_add_u32 m0, s27, 69632
  v_mfma_f32_16x16x32_bf16 v[160:163], v[32:35], v[48:51], v[160:163]
  ds_read_b64_tr_b16 v[98:99], v7 offset:45312
  s_add_u32 s4, s58, s65
  v_mfma_f32_16x16x32_bf16 v[164:167], v[20:23], v[52:55], v[164:167]
  buffer_load_dwordx4 v3, s[32:35], s4 offen lds
  v_mfma_f32_16x16x32_bf16 v[168:171], v[24:27], v[52:55], v[168:171]
  s_add_u32 s20, s20, 1
  s_and_b32 s20, s20, 7
  v_mfma_f32_16x16x32_bf16 v[172:175], v[28:31], v[52:55], v[172:175]
  s_mul_i32 s58, s20, s59
  s_lshl_b32 s21, s20, 7
  v_mfma_f32_16x16x32_bf16 v[176:179], v[32:35], v[52:55], v[176:179]
  s_add_u32 s21, s21, s57
  v_mfma_f32_16x16x32_bf16 v[180:183], v[20:23], v[56:59], v[180:183]
  s_lshl_b32 s3, s16, 5
  s_add_u32 m0, s70, 139264
  v_mfma_f32_16x16x32_bf16 v[184:187], v[24:27], v[56:59], v[184:187]
  s_add_u32 s4, s3, 0
  buffer_load_dwordx4 v10, s[44:47], s4 offen lds
  v_mfma_f32_16x16x32_bf16 v[188:191], v[28:31], v[56:59], v[188:191]
  s_add_u32 m0, s70, 140288
  v_mfma_f32_16x16x32_bf16 v[192:195], v[32:35], v[56:59], v[192:195]
  s_add_u32 s4, s3, 8192
  buffer_load_dwordx4 v10, s[44:47], s4 offen lds
  v_mfma_f32_16x16x32_bf16 v[196:199], v[16:19], v[20:23], v[196:199]
  s_add_u32 m0, s70, 141312
  s_add_u32 s4, s3, 16384
  v_mfma_f32_16x16x32_bf16 v[204:207], v[20:23], v[20:23], v[204:207]
  buffer_load_dwordx4 v10, s[44:47], s4 offen lds
  v_mfma_f32_16x16x32_bf16 v[200:203], v[16:19], v[24:27], v[200:203]
  s_add_u32 m0, s70, 142336
  s_add_u32 s4, s3, 24576
  v_mfma_f32_16x16x32_bf16 v[208:211], v[24:27], v[24:27], v[208:211]
  buffer_load_dwordx4 v10, s[44:47], s4 offen lds
  s_cmp_lg_u32 s25, 0
  s_cbranch_scc1 L_cs_10
  v_mfma_f32_16x16x32_bf16 v[212:215], v[16:19], v[36:39], v[212:215]
  v_mfma_f32_16x16x32_bf16 v[216:219], v[16:19], v[40:43], v[216:219]
  v_mfma_f32_16x16x32_bf16 v[220:223], v[16:19], v[44:47], v[220:223]
  v_mfma_f32_16x16x32_bf16 v[224:227], v[16:19], v[48:51], v[224:227]
  v_mfma_f32_16x16x32_bf16 v[228:231], v[16:19], v[52:55], v[228:231]
  v_mfma_f32_16x16x32_bf16 v[232:235], v[16:19], v[56:59], v[232:235]
L_cs_10:
  s_waitcnt vmcnt(18) lgkmcnt(0)
  s_barrier
  v_mfma_f32_16x16x32_bf16 v[100:103], v[76:79], v[60:63], v[100:103]
  ds_read_b128 v[20:23], v4 offset:32768
  s_add_u32 m0, s27, 16384
  v_mfma_f32_16x16x32_bf16 v[104:107], v[76:79], v[64:67], v[104:107]
  ds_read_b64_tr_b16 v[36:37], v8 offset:0
  v_mfma_f32_16x16x32_bf16 v[108:111], v[76:79], v[68:71], v[108:111]
  ds_read_b64_tr_b16 v[38:39], v8 offset:256
  s_add_u32 s4, s21, 0
  v_mfma_f32_16x16x32_bf16 v[112:115], v[76:79], v[72:75], v[112:115]
  ds_read_b128 v[24:27], v4 offset:34816
  v_mfma_f32_16x16x32_bf16 v[116:119], v[80:83], v[60:63], v[116:119]
  ds_read_b64_tr_b16 v[40:41], v9 offset:0
  v_mfma_f32_16x16x32_bf16 v[120:123], v[80:83], v[64:67], v[120:123]
  ds_read_b64_tr_b16 v[42:43], v9 offset:256
  buffer_load_dwordx4 v2, s[28:31], s4 offen lds
  v_mfma_f32_16x16x32_bf16 v[124:127], v[80:83], v[68:71], v[124:127]
  ds_read_b128 v[28:31], v5 offset:32768
  v_mfma_f32_16x16x32_bf16 v[128:131], v[80:83], v[72:75], v[128:131]
  ds_read_b128 v[32:35], v5 offset:34816
  v_mfma_f32_16x16x32_bf16 v[132:135], v[60:63], v[84:87], v[132:135]
  ds_read_b64_tr_b16 v[44:45], v8 offset:8192
  s_add_u32 m0, s27, 73728
  v_mfma_f32_16x16x32_bf16 v[136:139], v[64:67], v[84:87], v[136:139]
  ds_read_b64_tr_b16 v[46:47], v8 offset:8448
  v_mfma_f32_16x16x32_bf16 v[140:143], v[68:71], v[84:87], v[140:143]
  ds_read_b64_tr_b16 v[48:49], v9 offset:8192
  s_add_u32 s4, s58, s60
  v_mfma_f32_16x16x32_bf16 v[144:147], v[72:75], v[84:87], v[144:147]
  ds_read_b64_tr_b16 v[50:51], v9 offset:8448
  v_mfma_f32_16x16x32_bf16 v[148:151], v[60:63], v[88:91], v[148:151]
  ds_read_b64_tr_b16 v[52:53], v8 offset:16384
  v_mfma_f32_16x16x32_bf16 v[152:155], v[64:67], v[88:91], v[152:155]
  ds_read_b64_tr_b16 v[54:55], v8 offset:16640
  buffer_load_dwordx4 v3, s[32:35], s4 offen lds
  v_mfma_f32_16x16x32_bf16 v[156:159], v[68:71], v[88:91], v[156:159]
  ds_read_b64_tr_b16 v[56:57], v9 offset:16384
  v_mfma_f32_16x16x32_bf16 v[160:163], v[72:75], v[88:91], v[160:163]
  ds_read_b64_tr_b16 v[58:59], v9 offset:16640
  v_mfma_f32_16x16x32_bf16 v[164:167], v[60:63], v[92:95], v[164:167]
  s_add_u32 m0, s27, 81920
  v_mfma_f32_16x16x32_bf16 v[168:171], v[64:67], v[92:95], v[168:171]
  s_add_u32 s4, s58, s61
  v_mfma_f32_16x16x32_bf16 v[172:175], v[68:71], v[92:95], v[172:175]
  buffer_load_dwordx4 v3, s[32:35], s4 offen lds
  v_mfma_f32_16x16x32_bf16 v[176:179], v[72:75], v[92:95], v[176:179]
  v_mfma_f32_16x16x32_bf16 v[180:183], v[60:63], v[96:99], v[180:183]
  s_add_u32 m0, s27, 20480
  v_mfma_f32_16x16x32_bf16 v[184:187], v[64:67], v[96:99], v[184:187]
  s_add_u32 s4, s21, 32768
  v_mfma_f32_16x16x32_bf16 v[188:191], v[68:71], v[96:99], v[188:191]
  buffer_load_dwordx4 v2, s[28:31], s4 offen lds
  v_mfma_f32_16x16x32_bf16 v[192:195], v[72:75], v[96:99], v[192:195]
  v_mfma_f32_16x16x32_bf16 v[196:199], v[16:19], v[60:63], v[196:199]
  s_add_u32 m0, s27, 90112
  v_mfma_f32_16x16x32_bf16 v[204:207], v[60:63], v[60:63], v[204:207]
  s_add_u32 s4, s58, s62
  v_mfma_f32_16x16x32_bf16 v[200:203], v[16:19], v[64:67], v[200:203]
  buffer_load_dwordx4 v3, s[32:35], s4 offen lds
  v_mfma_f32_16x16x32_bf16 v[208:211], v[64:67], v[64:67], v[208:211]
  s_cmp_lg_u32 s25, 1
  s_cbranch_scc1 L_cs_11
  v_mfma_f32_16x16x32_bf16 v[212:215], v[16:19], v[76:79], v[212:215]
  v_mfma_f32_16x16x32_bf16 v[216:219], v[16:19], v[80:83], v[216:219]
  v_mfma_f32_16x16x32_bf16 v[220:223], v[16:19], v[84:87], v[220:223]
  v_mfma_f32_16x16x32_bf16 v[224:227], v[16:19], v[88:91], v[224:227]
  v_mfma_f32_16x16x32_bf16 v[228:231], v[16:19], v[92:95], v[228:231]
  v_mfma_f32_16x16x32_bf16 v[232:235], v[16:19], v[96:99], v[232:235]
L_cs_11:
  s_waitcnt lgkmcnt(0)
  v_mfma_f32_16x16x32_bf16 v[100:103], v[36:39], v[20:23], v[100:103]
  ds_read_b128 v[60:63], v4 offset:33280
  s_add_u32 m0, s27, 24576
  v_mfma_f32_16x16x32_bf16 v[104:107], v[36:39], v[24:27], v[104:107]
  ds_read_b64_tr_b16 v[76:77], v8 offset:4096
  s_add_u32 s4, s21, 65536
  v_mfma_f32_16x16x32_bf16 v[108:111], v[36:39], v[28:31], v[108:111]
  ds_read_b64_tr_b16 v[78:79], v8 offset:4352
  v_mfma_f32_16x16x32_bf16 v[112:115], v[36:39], v[32:35], v[112:115]
  ds_read_b128 v[64:67], v4 offset:35328
  buffer_load_dwordx4 v2, s[28:31], s4 offen lds
  v_mfma_f32_16x16x32_bf16 v[116:119], v[40:43], v[20:23], v[116:119]
  ds_read_b64_tr_b16 v[80:81], v9 offset:4096
  v_mfma_f32_16x16x32_bf16 v[120:123], v[40:43], v[24:27], v[120:123]
  ds_read_b64_tr_b16 v[82:83], v9 offset:4352
  s_add_u32 m0, s27, 77824
  v_mfma_f32_16x16x32_bf16 v[124:127], v[40:43], v[28:31], v[124:127]
  ds_read_b128 v[68:71], v5 offset:33280
  s_add_u32 s4, s58, s63
  v_mfma_f32_16x16x32_bf16 v[128:131], v[40:43], v[32:35], v[128:131]
  ds_read_b128 v[72:75], v5 offset:35328
  v_mfma_f32_16x16x32_bf16 v[132:135], v[20:23], v[44:47], v[132:135]
  ds_read_b64_tr_b16 v[84:85], v8 offset:12288
  buffer_load_dwordx4 v3, s[32:35], s4 offen lds
  v_mfma_f32_16x16x32_bf16 v[136:139], v[24:27], v[44:47], v[136:139]
  ds_read_b64_tr_b16 v[86:87], v8 offset:12544
  v_mfma_f32_16x16x32_bf16 v[140:143], v[28:31], v[44:47], v[140:143]
  ds_read_b64_tr_b16 v[88:89], v9 offset:12288
  s_add_u32 m0, s27, 86016
  v_mfma_f32_16x16x32_bf16 v[144:147], v[32:35], v[44:47], v[144:147]
  ds_read_b64_tr_b16 v[90:91], v9 offset:12544
  s_add_u32 s4, s58, s64
  v_mfma_f32_16x16x32_bf16 v[148:151], v[20:23], v[48:51], v[148:151]
  ds_read_b64_tr_b16 v[92:93], v8 offset:20480
  v_mfma_f32_16x16x32_bf16 v[152:155], v[24:27], v[48:51], v[152:155]
  ds_read_b64_tr_b16 v[94:95], v8 offset:20736
  buffer_load_dwordx4 v3, s[32:35], s4 offen lds
  v_mfma_f32_16x16x32_bf16 v[156:159], v[28:31], v[48:51], v[156:159]
  ds_read_b64_tr_b16 v[96:97], v9 offset:20480
  v_mfma_f32_16x16x32_bf16 v[160:163], v[32:35], v[48:51], v[160:163]
  ds_read_b64_tr_b16 v[98:99], v9 offset:20736
  s_add_u32 m0, s27, 28672
  v_mfma_f32_16x16x32_bf16 v[164:167], v[20:23], v[52:55], v[164:167]
  s_add_u32 s4, s21, 98304
  v_mfma_f32_16x16x32_bf16 v[168:171], v[24:27], v[52:55], v[168:171]
  buffer_load_dwordx4 v2, s[28:31], s4 offen lds
  v_mfma_f32_16x16x32_bf16 v[172:175], v[28:31], v[52:55], v[172:175]
  s_add_u32 m0, s27, 94208
  s_add_u32 s4, s58, s65
  v_mfma_f32_16x16x32_bf16 v[176:179], v[32:35], v[52:55], v[176:179]
  buffer_load_dwordx4 v3, s[32:35], s4 offen lds
  v_mfma_f32_16x16x32_bf16 v[180:183], v[20:23], v[56:59], v[180:183]
  s_getpc_b64 s[82:83]
L_cp_12:
  v_mfma_f32_16x16x32_bf16 v[184:187], v[24:27], v[56:59], v[184:187]
  s_bfe_u32 s72, s2, 0x20003
  v_mfma_f32_16x16x32_bf16 v[188:191], v[28:31], v[56:59], v[188:191]
  s_lshl_b32 s73, s24, 6
  v_mfma_f32_16x16x32_bf16 v[192:195], v[32:35], v[56:59], v[192:195]
  s_add_u32 s72, s72, s73
  v_and_b32 v13, 15, v1
  v_mfma_f32_16x16x32_bf16 v[196:199], v[16:19], v[20:23], v[196:199]
  v_lshl_add_u32 v13, v13, 2, s72
  v_mfma_f32_16x16x32_bf16 v[204:207], v[20:23], v[20:23], v[204:207]
  v_lshlrev_b32 v13, 7, v13
  v_mfma_f32_16x16x32_bf16 v[200:203], v[16:19], v[24:27], v[200:203]
  v_min_u32 v13, L_code_end - L_cp_12 - 4, v13
  v_mfma_f32_16x16x32_bf16 v[208:211], v[24:27], v[24:27], v[208:211]
  global_load_dword v255, v13, s[82:83]
  s_cmp_lg_u32 s25, 0
  s_cbranch_scc1 L_cs_13
  v_mfma_f32_16x16x32_bf16 v[212:215], v[16:19], v[36:39], v[212:215]
  v_mfma_f32_16x16x32_bf16 v[216:219], v[16:19], v[40:43], v[216:219]
  v_mfma_f32_16x16x32_bf16 v[220:223], v[16:19], v[44:47], v[220:223]
  v_mfma_f32_16x16x32_bf16 v[224:227], v[16:19], v[48:51], v[224:227]
  v_mfma_f32_16x16x32_bf16 v[228:231], v[16:19], v[52:55], v[228:231]
  v_mfma_f32_16x16x32_bf16 v[232:235], v[16:19], v[56:59], v[232:235]
L_cs_13:
  s_waitcnt vmcnt(15) lgkmcnt(0)
  s_barrier
  v_mfma_f32_16x16x32_bf16 v[100:103], v[76:79], v[60:63], v[100:103]
  ds_read_b128 v[20:23], v4 offset:0
  s_waitcnt vmcnt(25)
  v_mfma_f32_16x16x32_bf16 v[104:107], v[76:79], v[64:67], v[104:107]
  ds_read_b64_tr_b16 v[36:37], v6 offset:0
  v_add_u32 v248, 122880, v11
  v_mfma_f32_16x16x32_bf16 v[108:111], v[76:79], v[68:71], v[108:111]
  ds_read_b64_tr_b16 v[38:39], v6 offset:256
  v_mfma_f32_16x16x32_bf16 v[112:115], v[76:79], v[72:75], v[112:115]
  ds_read_b128 v[24:27], v4 offset:2048
  v_add_u32 v249, 122880, v12
  v_mfma_f32_16x16x32_bf16 v[116:119], v[80:83], v[60:63], v[116:119]
  ds_read_b64_tr_b16 v[40:41], v7 offset:0
  v_mfma_f32_16x16x32_bf16 v[120:123], v[80:83], v[64:67], v[120:123]
  ds_read_b64_tr_b16 v[42:43], v7 offset:256
  ds_read_b64_tr_b16 a[0:1], v248 offset:0
  v_mfma_f32_16x16x32_bf16 v[124:127], v[80:83], v[68:71], v[124:127]
  ds_read_b128 v[28:31], v5 offset:0
  ds_read_b64_tr_b16 a[2:3], v248 offset:2048
  v_mfma_f32_16x16x32_bf16 v[128:131], v[80:83], v[72:75], v[128:131]
  ds_read_b128 v[32:35], v5 offset:2048
  v_mfma_f32_16x16x32_bf16 v[132:135], v[60:63], v[84:87], v[132:135]
  ds_read_b64_tr_b16 v[44:45], v6 offset:8192
  ds_read_b64_tr_b16 a[4:5], v249 offset:0
  v_mfma_f32_16x16x32_bf16 v[136:139], v[64:67], v[84:87], v[136:139]
  ds_read_b64_tr_b16 v[46:47], v6 offset:8448
  v_mfma_f32_16x16x32_bf16 v[140:143], v[68:71], v[84:87], v[140:143]
  ds_read_b64_tr_b16 v[48:49], v7 offset:8192
  ds_read_b64_tr_b16 a[6:7], v249 offset:2048
  v_mfma_f32_16x16x32_bf16 v[144:147], v[72:75], v[84:87], v[144:147]
  ds_read_b64_tr_b16 v[50:51], v7 offset:8448
  ds_read_b64_tr_b16 a[8:9], v248 offset:512
  v_mfma_f32_16x16x32_bf16 v[148:151], v[60:63], v[88:91], v[148:151]
  ds_read_b64_tr_b16 v[52:53], v6 offset:16384
  v_mfma_f32_16x16x32_bf16 v[152:155], v[64:67], v[88:91], v[152:155]
  ds_read_b64_tr_b16 v[54:55], v6 offset:16640
  ds_read_b64_tr_b16 a[10:11], v248 offset:2560
  v_mfma_f32_16x16x32_bf16 v[156:159], v[68:71], v[88:91], v[156:159]
  ds_read_b64_tr_b16 v[56:57], v7 offset:16384
  v_mfma_f32_16x16x32_bf16 v[160:163], v[72:75], v[88:91], v[160:163]
  ds_read_b64_tr_b16 v[58:59], v7 offset:16640
  ds_read_b64_tr_b16 a[12:13], v249 offset:512
  v_mfma_f32_16x16x32_bf16 v[164:167], v[60:63], v[92:95], v[164:167]
  ds_read_b64_tr_b16 a[14:15], v249 offset:2560
  v_mfma_f32_16x16x32_bf16 v[168:171], v[64:67], v[92:95], v[168:171]
  s_lshl_b32 s3, s6, 5
  v_mfma_f32_16x16x32_bf16 v[172:175], v[68:71], v[92:95], v[172:175]
  s_add_u32 m0, s70, 32768
  s_add_u32 s4, s3, 0
  v_mfma_f32_16x16x32_bf16 v[176:179], v[72:75], v[92:95], v[176:179]
  buffer_load_dwordx4 v10, s[40:43], s4 offen lds
  v_mfma_f32_16x16x32_bf16 v[180:183], v[60:63], v[96:99], v[180:183]
  s_add_u32 m0, s70, 33792
  v_mfma_f32_16x16x32_bf16 v[184:187], v[64:67], v[96:99], v[184:187]
  s_add_u32 s4, s3, 8192
  v_mfma_f32_16x16x32_bf16 v[188:191], v[68:71], v[96:99], v[188:191]
  buffer_load_dwordx4 v10, s[40:43], s4 offen lds
  v_mfma_f32_16x16x32_bf16 v[192:195], v[72:75], v[96:99], v[192:195]
  s_add_u32 m0, s70, 34816
  s_add_u32 s4, s3, 16384
  v_mfma_f32_16x16x32_bf16 v[196:199], v[16:19], v[60:63], v[196:199]
  buffer_load_dwordx4 v10, s[40:43], s4 offen lds
  v_mfma_f32_16x16x32_bf16 v[204:207], v[60:63], v[60:63], v[204:207]
  s_add_u32 m0, s70, 35840
  v_mfma_f32_16x16x32_bf16 v[200:203], v[16:19], v[64:67], v[200:203]
  s_add_u32 s4, s3, 24576
  v_mfma_f32_16x16x32_bf16 v[208:211], v[64:67], v[64:67], v[208:211]
  buffer_load_dwordx4 v10, s[40:43], s4 offen lds
  s_cmp_lg_u32 s25, 1
  s_cbranch_scc1 L_cs_14
  v_mfma_f32_16x16x32_bf16 v[212:215], v[16:19], v[76:79], v[212:215]
  v_mfma_f32_16x16x32_bf16 v[216:219], v[16:19], v[80:83], v[216:219]
  v_mfma_f32_16x16x32_bf16 v[220:223], v[16:19], v[84:87], v[220:223]
  v_mfma_f32_16x16x32_bf16 v[224:227], v[16:19], v[88:91], v[224:227]
  v_mfma_f32_16x16x32_bf16 v[228:231], v[16:19], v[92:95], v[228:231]
  v_mfma_f32_16x16x32_bf16 v[232:235], v[16:19], v[96:99], v[232:235]
L_cs_14:
  s_waitcnt lgkmcnt(0)
  v_mfma_f32_16x16x32_bf16 v[100:103], v[36:39], v[20:23], v[100:103]
  ds_read_b128 v[60:63], v4 offset:512
  v_lshrrev_b32 v14, 3, v1
  v_mfma_f32_16x16x32_bf16 v[104:107], v[36:39], v[24:27], v[104:107]
  ds_read_b64_tr_b16 v[76:77], v6 offset:4096
  v_lshlrev_b32 v14, 10, v14
  v_mfma_f32_16x16x32_bf16 v[108:111], v[36:39], v[28:31], v[108:111]
  ds_read_b64_tr_b16 v[78:79], v6 offset:4352
  v_and_b32 v15, 7, v1
  v_mfma_f32_16x16x32_bf16 v[112:115], v[36:39], v[32:35], v[112:115]
  ds_read_b128 v[64:67], v4 offset:2560
  v_lshl_add_u32 v14, v15, 4, v14
  v_mfma_f32_16x16x32_bf16 v[116:119], v[40:43], v[20:23], v[116:119]
  ds_read_b64_tr_b16 v[80:81], v7 offset:4096
  s_lshl_b32 s72, s24, 11
  v_mfma_f32_16x16x32_bf16 v[120:123], v[40:43], v[24:27], v[120:123]
  ds_read_b64_tr_b16 v[82:83], v7 offset:4352
  s_add_u32 m0, s72, 114688
  v_mfma_f32_16x16x32_bf16 v[124:127], v[40:43], v[28:31], v[124:127]
  ds_read_b128 v[68:71], v5 offset:512
  s_nop 0
  v_mfma_f32_16x16x32_bf16 v[128:131], v[40:43], v[32:35], v[128:131]
  ds_read_b128 v[72:75], v5 offset:2560
  v_mfma_f32_16x16x32_bf16 v[132:135], v[20:23], v[44:47], v[132:135]
  ds_read_b64_tr_b16 v[84:85], v6 offset:12288
  buffer_load_dwordx4 v14, s[28:31], s93 offen lds
  v_mfma_f32_16x16x32_bf16 v[136:139], v[24:27], v[44:47], v[136:139]
  ds_read_b64_tr_b16 v[86:87], v6 offset:12544
  s_add_u32 m0, s72, 115712
  v_mfma_f32_16x16x32_bf16 v[140:143], v[28:31], v[44:47], v[140:143]
  ds_read_b64_tr_b16 v[88:89], v7 offset:12288
  s_add_u32 s4, s93, 8192
  v_mfma_f32_16x16x32_bf16 v[144:147], v[32:35], v[44:47], v[144:147]
  ds_read_b64_tr_b16 v[90:91], v7 offset:12544
  buffer_load_dwordx4 v14, s[28:31], s4 offen lds
  v_mfma_f32_16x16x32_bf16 v[148:151], v[20:23], v[48:51], v[148:151]
  ds_read_b64_tr_b16 v[92:93], v6 offset:20480
  s_waitcnt vmcnt(17)
  v_mfma_f32_16x16x32_bf16 v[152:155], v[24:27], v[48:51], v[152:155]
  ds_read_b64_tr_b16 v[94:95], v6 offset:20736
  v_add_u32 v250, 139264, v11
  v_mfma_f32_16x16x32_bf16 v[156:159], v[28:31], v[48:51], v[156:159]
  ds_read_b64_tr_b16 v[96:97], v7 offset:20480
  v_add_u32 v251, 139264, v12
  v_mfma_f32_16x16x32_bf16 v[160:163], v[32:35], v[48:51], v[160:163]
  ds_read_b64_tr_b16 v[98:99], v7 offset:20736
  v_mfma_f32_16x16x32_bf16 v[164:167], v[20:23], v[52:55], v[164:167]
  ds_read_b64_tr_b16 a[176:177], v250 offset:0
  ds_read_b64_tr_b16 a[178:179], v250 offset:2048
  v_mfma_f32_16x16x32_bf16 v[168:171], v[24:27], v[52:55], v[168:171]
  ds_read_b64_tr_b16 a[180:181], v251 offset:0
  ds_read_b64_tr_b16 a[182:183], v251 offset:2048
  v_mfma_f32_16x16x32_bf16 v[172:175], v[28:31], v[52:55], v[172:175]
  ds_read_b64_tr_b16 a[184:185], v250 offset:512
  ds_read_b64_tr_b16 a[186:187], v250 offset:2560
  v_mfma_f32_16x16x32_bf16 v[176:179], v[32:35], v[52:55], v[176:179]
  ds_read_b64_tr_b16 a[188:189], v251 offset:512
  v_mfma_f32_16x16x32_bf16 v[180:183], v[20:23], v[56:59], v[180:183]
  ds_read_b64_tr_b16 a[190:191], v251 offset:2560
  s_lshl_b32 s3, s7, 5
  v_mfma_f32_16x16x32_bf16 v[184:187], v[24:27], v[56:59], v[184:187]
  s_add_u32 m0, s70, 98304
  s_add_u32 s4, s3, 0
  v_mfma_f32_16x16x32_bf16 v[188:191], v[28:31], v[56:59], v[188:191]
  buffer_load_dwordx4 v10, s[40:43], s4 offen lds
  s_add_u32 m0, s70, 99328
  v_mfma_f32_16x16x32_bf16 v[192:195], v[32:35], v[56:59], v[192:195]
  s_add_u32 s4, s3, 8192
  v_mfma_f32_16x16x32_bf16 v[196:199], v[16:19], v[20:23], v[196:199]
  buffer_load_dwordx4 v10, s[40:43], s4 offen lds
  s_add_u32 m0, s70, 100352
  v_mfma_f32_16x16x32_bf16 v[204:207], v[20:23], v[20:23], v[204:207]
  s_add_u32 s4, s3, 16384
  buffer_load_dwordx4 v10, s[40:43], s4 offen lds
  v_mfma_f32_16x16x32_bf16 v[200:203], v[16:19], v[24:27], v[200:203]
  s_add_u32 m0, s70, 101376
  s_add_u32 s4, s3, 24576
  v_mfma_f32_16x16x32_bf16 v[208:211], v[24:27], v[24:27], v[208:211]
  buffer_load_dwordx4 v10, s[40:43], s4 offen lds
  s_cmp_lg_u32 s25, 0
  s_cbranch_scc1 L_cs_15
  v_mfma_f32_16x16x32_bf16 v[212:215], v[16:19], v[36:39], v[212:215]
  v_mfma_f32_16x16x32_bf16 v[216:219], v[16:19], v[40:43], v[216:219]
  v_mfma_f32_16x16x32_bf16 v[220:223], v[16:19], v[44:47], v[220:223]
  v_mfma_f32_16x16x32_bf16 v[224:227], v[16:19], v[48:51], v[224:227]
  v_mfma_f32_16x16x32_bf16 v[228:231], v[16:19], v[52:55], v[228:231]
  v_mfma_f32_16x16x32_bf16 v[232:235], v[16:19], v[56:59], v[232:235]
L_cs_15:
  s_waitcnt vmcnt(11) lgkmcnt(0)
  s_barrier
  v_mfma_f32_16x16x32_bf16 v[100:103], v[76:79], v[60:63], v[100:103]
  ds_read_b128 v[20:23], v4 offset:16384
  s_lshl_b32 s3, s8, 5
  v_mfma_f32_16x16x32_bf16 v[104:107], v[76:79], v[64:67], v[104:107]
  ds_read_b64_tr_b16 v[36:37], v6 offset:24576
  s_add_u32 m0, s70, 0
  v_mfma_f32_16x16x32_bf16 v[108:111], v[76:79], v[68:71], v[108:111]
  ds_read_b64_tr_b16 v[38:39], v6 offset:24832
  s_add_u32 s4, s3, 0
  v_mfma_f32_16x16x32_bf16 v[112:115], v[76:79], v[72:75], v[112:115]
  ds_read_b128 v[24:27], v4 offset:18432
  v_mfma_f32_16x16x32_bf16 v[116:119], v[80:83], v[60:63], v[116:119]
  ds_read_b64_tr_b16 v[40:41], v7 offset:24576
  buffer_load_dwordx4 v10, s[40:43], s4 offen lds
  v_mfma_f32_16x16x32_bf16 v[120:123], v[80:83], v[64:67], v[120:123]
  ds_read_b64_tr_b16 v[42:43], v7 offset:24832
  s_add_u32 m0, s70, 1024
  v_mfma_f32_16x16x32_bf16 v[124:127], v[80:83], v[68:71], v[124:127]
  ds_read_b128 v[28:31], v5 offset:16384
  v_mfma_f32_16x16x32_bf16 v[128:131], v[80:83], v[72:75], v[128:131]
  ds_read_b128 v[32:35], v5 offset:18432
  s_add_u32 s4, s3, 8192
  v_mfma_f32_16x16x32_bf16 v[132:135], v[60:63], v[84:87], v[132:135]
  ds_read_b64_tr_b16 v[44:45], v6 offset:32768
  buffer_load_dwordx4 v10, s[40:43], s4 offen lds
  v_mfma_f32_16x16x32_bf16 v[136:139], v[64:67], v[84:87], v[136:139]
  ds_read_b64_tr_b16 v[46:47], v6 offset:33024
  v_mfma_f32_16x16x32_bf16 v[140:143], v[68:71], v[84:87], v[140:143]
  ds_read_b64_tr_b16 v[48:49], v7 offset:32768
  s_add_u32 m0, s70, 2048
  v_mfma_f32_16x16x32_bf16 v[144:147], v[72:75], v[84:87], v[144:147]
  ds_read_b64_tr_b16 v[50:51], v7 offset:33024
  s_add_u32 s4, s3, 16384
  v_mfma_f32_16x16x32_bf16 v[148:151], v[60:63], v[88:91], v[148:151]
  ds_read_b64_tr_b16 v[52:53], v6 offset:40960
  v_mfma_f32_16x16x32_bf16 v[152:155], v[64:67], v[88:91], v[152:155]
  ds_read_b64_tr_b16 v[54:55], v6 offset:41216
  buffer_load_dwordx4 v10, s[40:43], s4 offen lds
  v_mfma_f32_16x16x32_bf16 v[156:159], v[68:71], v[88:91], v[156:159]
  ds_read_b64_tr_b16 v[56:57], v7 offset:40960
  s_add_u32 m0, s70, 3072
  v_mfma_f32_16x16x32_bf16 v[160:163], v[72:75], v[88:91], v[160:163]
  ds_read_b64_tr_b16 v[58:59], v7 offset:41216
  v_mfma_f32_16x16x32_bf16 v[164:167], v[60:63], v[92:95], v[164:167]
  s_add_u32 s4, s3, 24576
  buffer_load_dwordx4 v10, s[40:43], s4 offen lds
  v_mfma_f32_16x16x32_bf16 v[168:171], v[64:67], v[92:95], v[168:171]
  s_lshl_b32 s3, s9, 5
  v_mfma_f32_16x16x32_bf16 v[172:175], v[68:71], v[92:95], v[172:175]
  s_add_u32 m0, s70, 122880
  v_mfma_f32_16x16x32_bf16 v[176:179], v[72:75], v[92:95], v[176:179]
  s_add_u32 s4, s3, 0
  buffer_load_dwordx4 v10, s[40:43], s4 offen lds
  v_mfma_f32_16x16x32_bf16 v[180:183], v[60:63], v[96:99], v[180:183]
  s_add_u32 m0, s70, 123904
  v_mfma_f32_16x16x32_bf16 v[184:187], v[64:67], v[96:99], v[184:187]
  s_add_u32 s4, s3, 8192
  v_mfma_f32_16x16x32_bf16 v[188:191], v[68:71], v[96:99], v[188:191]
  buffer_load_dwordx4 v10, s[40:43], s4 offen lds
  s_add_u32 m0, s70, 124928
  v_mfma_f32_16x16x32_bf16 v[192:195], v[72:75], v[96:99], v[192:195]
  s_add_u32 s4, s3, 16384
  v_mfma_f32_16x16x32_bf16 v[196:199], v[16:19], v[60:63], v[196:199]
  buffer_load_dwordx4 v10, s[40:43], s4 offen lds
  v_mfma_f32_16x16x32_bf16 v[204:207], v[60:63], v[60:63], v[204:207]
  s_add_u32 m0, s70, 125952
  s_add_u32 s4, s3, 24576
  v_mfma_f32_16x16x32_bf16 v[200:203], v[16:19], v[64:67], v[200:203]
  buffer_load_dwordx4 v10, s[40:43], s4 offen lds
  v_mfma_f32_16x16x32_bf16 v[208:211], v[64:67], v[64:67], v[208:211]
  buffer_load_dword v254, v252, s[52:55], 8 offen sc1
  s_cmp_lg_u32 s25, 1
  s_cbranch_scc1 L_cs_16
  v_mfma_f32_16x16x32_bf16 v[212:215], v[16:19], v[76:79], v[212:215]
  v_mfma_f32_16x16x32_bf16 v[216:219], v[16:19], v[80:83], v[216:219]
  v_mfma_f32_16x16x32_bf16 v[220:223], v[16:19], v[84:87], v[220:223]
  v_mfma_f32_16x16x32_bf16 v[224:227], v[16:19], v[88:91], v[224:227]
  v_mfma_f32_16x16x32_bf16 v[228:231], v[16:19], v[92:95], v[228:231]
  v_mfma_f32_16x16x32_bf16 v[232:235], v[16:19], v[96:99], v[232:235]
L_cs_16:
  s_waitcnt lgkmcnt(0)
  v_mfma_f32_16x16x32_bf16 v[196:199], v[16:19], v[20:23], v[196:199]
  ds_read_b128 v[60:63], v4 offset:16896
  ds_read_b64_tr_b16 v[76:77], v6 offset:28672
  v_mfma_f32_16x16x32_bf16 v[204:207], v[20:23], v[20:23], v[204:207]
  ds_read_b64_tr_b16 v[78:79], v6 offset:28928
  ds_read_b128 v[64:67], v4 offset:18944
  v_mfma_f32_16x16x32_bf16 v[200:203], v[16:19], v[24:27], v[200:203]
  ds_read_b64_tr_b16 v[80:81], v7 offset:28672
  ds_read_b64_tr_b16 v[82:83], v7 offset:28928
  v_mfma_f32_16x16x32_bf16 v[208:211], v[24:27], v[24:27], v[208:211]
  ds_read_b128 v[68:71], v5 offset:16896
  ds_read_b128 v[72:75], v5 offset:18944
  v_mfma_f32_16x16x32_bf16 v[132:135], v[20:23], v[44:47], v[132:135]
  ds_read_b64_tr_b16 v[84:85], v6 offset:36864
  ds_read_b64_tr_b16 v[86:87], v6 offset:37120
  v_mfma_f32_16x16x32_bf16 v[136:139], v[24:27], v[44:47], v[136:139]
  ds_read_b64_tr_b16 v[88:89], v7 offset:36864
  ds_read_b64_tr_b16 v[90:91], v7 offset:37120
  v_mfma_f32_16x16x32_bf16 v[140:143], v[28:31], v[44:47], v[140:143]
  ds_read_b64_tr_b16 v[92:93], v6 offset:45056
  ds_read_b64_tr_b16 v[94:95], v6 offset:45312
  v_mfma_f32_16x16x32_bf16 v[144:147], v[32:35], v[44:47], v[144:147]
  ds_read_b64_tr_b16 v[96:97], v7 offset:45056
  ds_read_b64_tr_b16 v[98:99], v7 offset:45312
  v_mfma_f32_16x16x32_bf16 v[164:167], v[20:23], v[52:55], v[164:167]
  v_mfma_f32_16x16x32_bf16 v[168:171], v[24:27], v[52:55], v[168:171]
  v_mfma_f32_16x16x32_bf16 v[172:175], v[28:31], v[52:55], v[172:175]
  v_mfma_f32_16x16x32_bf16 v[176:179], v[32:35], v[52:55], v[176:179]
  s_cmp_lg_u32 s25, 0
  s_cbranch_scc1 L_cs_17
  v_mfma_f32_16x16x32_bf16 v[212:215], v[16:19], v[36:39], v[212:215]
  v_mfma_f32_16x16x32_bf16 v[216:219], v[16:19], v[40:43], v[216:219]
  v_mfma_f32_16x16x32_bf16 v[220:223], v[16:19], v[44:47], v[220:223]
  v_mfma_f32_16x16x32_bf16 v[224:227], v[16:19], v[48:51], v[224:227]
  v_mfma_f32_16x16x32_bf16 v[228:231], v[16:19], v[52:55], v[228:231]
  v_mfma_f32_16x16x32_bf16 v[232:235], v[16:19], v[56:59], v[232:235]
L_cs_17:
  s_waitcnt lgkmcnt(0)
  v_mfma_f32_16x16x32_bf16 v[196:199], v[16:19], v[60:63], v[196:199]
  v_mfma_f32_16x16x32_bf16 v[204:207], v[60:63], v[60:63], v[204:207]
  v_mfma_f32_16x16x32_bf16 v[200:203], v[16:19], v[64:67], v[200:203]
  v_mfma_f32_16x16x32_bf16 v[208:211], v[64:67], v[64:67], v[208:211]
  s_cmp_lg_u32 s25, 1
  s_cbranch_scc1 L_cs_18
  v_mfma_f32_16x16x32_bf16 v[212:215], v[16:19], v[76:79], v[212:215]
  v_mfma_f32_16x16x32_bf16 v[216:219], v[16:19], v[80:83], v[216:219]
  v_mfma_f32_16x16x32_bf16 v[220:223], v[16:19], v[84:87], v[220:223]
  v_mfma_f32_16x16x32_bf16 v[224:227], v[16:19], v[88:91], v[224:227]
  v_mfma_f32_16x16x32_bf16 v[228:231], v[16:19], v[92:95], v[228:231]
  v_mfma_f32_16x16x32_bf16 v[232:235], v[16:19], v[96:99], v[232:235]
L_cs_18:
  v_mfma_f32_16x16x32_bf16 v[148:151], v[20:23], v[48:51], v[148:151]
  s_lshl_b32 s3, s10, 5
  s_add_u32 m0, s70, 49152
  v_mfma_f32_16x16x32_bf16 v[152:155], v[24:27], v[48:51], v[152:155]
  s_add_u32 s4, s3, 0
  buffer_load_dwordx4 v10, s[40:43], s4 offen lds
  v_mfma_f32_16x16x32_bf16 v[156:159], v[28:31], v[48:51], v[156:159]
  s_add_u32 m0, s70, 50176
  s_add_u32 s4, s3, 8192
  v_mfma_f32_16x16x32_bf16 v[160:163], v[32:35], v[48:51], v[160:163]
  buffer_load_dwordx4 v10, s[40:43], s4 offen lds
  s_add_u32 m0, s70, 51200
  v_mfma_f32_16x16x32_bf16 v[180:183], v[20:23], v[56:59], v[180:183]
  s_add_u32 s4, s3, 16384
  buffer_load_dwordx4 v10, s[40:43], s4 offen lds
  v_mfma_f32_16x16x32_bf16 v[184:187], v[24:27], v[56:59], v[184:187]
  ds_write_b32 v237, v212 offset:0
  ds_write_b32 v237, v216 offset:64
  v_mfma_f32_16x16x32_bf16 v[188:191], v[28:31], v[56:59], v[188:191]
  ds_write_b32 v237, v220 offset:128
  ds_write_b32 v237, v224 offset:192
  v_mfma_f32_16x16x32_bf16 v[192:195], v[32:35], v[56:59], v[192:195]
  ds_write_b32 v237, v228 offset:256
  ds_write_b32 v237, v232 offset:320
  v_mfma_f32_16x16x32_bf16 v[100:103], v[36:39], v[20:23], v[100:103]
  v_cndmask_b32 v204, v204, v205, s[94:95]
  v_cndmask_b32 v204, v204, v206, s[96:97]
  v_mfma_f32_16x16x32_bf16 v[104:107], v[36:39], v[24:27], v[104:107]
  v_cndmask_b32 v204, v204, v207, s[98:99]
  v_cndmask_b32 v208, v208, v209, s[94:95]
  v_mfma_f32_16x16x32_bf16 v[108:111], v[36:39], v[28:31], v[108:111]
  v_cndmask_b32 v208, v208, v210, s[96:97]
  v_cndmask_b32 v208, v208, v211, s[98:99]
  v_mfma_f32_16x16x32_bf16 v[112:115], v[36:39], v[32:35], v[112:115]
  v_mul_f32 v196, 0x3b000000, v196
  v_mul_f32 v200, 0x3b000000, v200
  v_mfma_f32_16x16x32_bf16 v[116:119], v[40:43], v[20:23], v[116:119]
  v_mul_f32 v204, 0x3b000000, v204
  v_mul_f32 v208, 0x3b000000, v208
  v_mfma_f32_16x16x32_bf16 v[120:123], v[40:43], v[24:27], v[120:123]
  v_fma_f32 v204, -v196, v196, v204
  v_fma_f32 v208, -v200, v200, v208
  v_mfma_f32_16x16x32_bf16 v[124:127], v[40:43], v[28:31], v[124:127]
  v_max_f32 v204, 0, v204
  v_max_f32 v208, 0, v208
  v_mfma_f32_16x16x32_bf16 v[128:131], v[40:43], v[32:35], v[128:131]
  v_cvt_pk_bf16_f32 v247, v204, v208
  v_lshlrev_b32 v204, 16, v247
  v_mfma_f32_16x16x32_bf16 v[132:135], v[60:63], v[84:87], v[132:135]
  v_and_b32 v208, 0xffff0000, v247
  v_mfma_f32_16x16x32_bf16 v[136:139], v[64:67], v[84:87], v[136:139]
  v_add_f32 v204, 0x3727c5ac, v204
  v_add_f32 v208, 0x3727c5ac, v208
  v_mfma_f32_16x16x32_bf16 v[140:143], v[68:71], v[84:87], v[140:143]
  v_cvt_pk_bf16_f32 v247, v204, v208
  v_lshlrev_b32 v204, 16, v247
  v_mfma_f32_16x16x32_bf16 v[144:147], v[72:75], v[84:87], v[144:147]
  v_and_b32 v208, 0xffff0000, v247
  v_sqrt_f32 v204, v204
  v_mfma_f32_16x16x32_bf16 v[164:167], v[60:63], v[92:95], v[164:167]
  v_sqrt_f32 v208, v208
  v_cvt_pk_bf16_f32 v247, v196, v200
  v_mfma_f32_16x16x32_bf16 v[168:171], v[64:67], v[92:95], v[168:171]
  v_lshlrev_b32 v196, 16, v247
  v_and_b32 v200, 0xffff0000, v247
  v_mfma_f32_16x16x32_bf16 v[172:175], v[68:71], v[92:95], v[172:175]
  v_cvt_pk_bf16_f32 v247, v204, v208
  v_lshlrev_b32 v204, 16, v247
  v_mfma_f32_16x16x32_bf16 v[176:179], v[72:75], v[92:95], v[176:179]
  v_and_b32 v208, 0xffff0000, v247
  v_rcp_f32 v204, v204
  v_mfma_f32_16x16x32_bf16 v[148:151], v[60:63], v[88:91], v[148:151]
  v_rcp_f32 v208, v208
  v_sub_f32 v196, 0, v196
  v_mfma_f32_16x16x32_bf16 v[152:155], v[64:67], v[88:91], v[152:155]
  v_sub_f32 v200, 0, v200
  ds_write_b32 v236, v196
  v_mfma_f32_16x16x32_bf16 v[156:159], v[68:71], v[88:91], v[156:159]
  ds_write_b32 v236, v200 offset:64
  ds_write_b32 v236, v204 offset:512
  v_mfma_f32_16x16x32_bf16 v[160:163], v[72:75], v[88:91], v[160:163]
  ds_write_b32 v236, v208 offset:576
  s_waitcnt lgkmcnt(0)
  s_barrier
  v_mfma_f32_16x16x32_bf16 v[180:183], v[60:63], v[96:99], v[180:183]
  ds_read_b32 v52, v245 offset:128
  ds_read_b32 v56, v245 offset:896
  v_mfma_f32_16x16x32_bf16 v[184:187], v[64:67], v[96:99], v[184:187]
  ds_read_b32 v53, v245 offset:192
  ds_read_b32 v57, v245 offset:960
  v_mfma_f32_16x16x32_bf16 v[188:191], v[68:71], v[96:99], v[188:191]
  ds_read_b32 v54, v245 offset:256
  ds_read_b32 v58, v245 offset:1024
  v_mfma_f32_16x16x32_bf16 v[192:195], v[72:75], v[96:99], v[192:195]
  ds_read_b32 v55, v245 offset:320
  ds_read_b32 v59, v245 offset:1088
  v_mfma_f32_16x16x32_bf16 v[100:103], v[76:79], v[60:63], v[100:103]
  ds_read_b128 v[20:23], v243 offset:0
  ds_read_b128 v[36:39], v243 offset:512
  v_mfma_f32_16x16x32_bf16 v[104:107], v[76:79], v[64:67], v[104:107]
  ds_read_b128 v[24:27], v243 offset:64
  ds_read_b128 v[40:43], v243 offset:576
  v_mfma_f32_16x16x32_bf16 v[108:111], v[76:79], v[68:71], v[108:111]
  ds_read_b128 v[28:31], v244 offset:128
  ds_read_b128 v[44:47], v244 offset:640
  v_mfma_f32_16x16x32_bf16 v[112:115], v[76:79], v[72:75], v[112:115]
  ds_read_b128 v[32:35], v244 offset:192
  ds_read_b128 v[48:51], v244 offset:704
  v_mfma_f32_16x16x32_bf16 v[116:119], v[80:83], v[60:63], v[116:119]
  v_mfma_f32_16x16x32_bf16 v[120:123], v[80:83], v[64:67], v[120:123]
  v_mfma_f32_16x16x32_bf16 v[124:127], v[80:83], v[68:71], v[124:127]
  v_mfma_f32_16x16x32_bf16 v[128:131], v[80:83], v[72:75], v[128:131]
  v_lshlrev_b32 v239, 2, v1
  v_mov_b32 v200, 1.0
  v_mov_b32 v201, 1.0
  v_mov_b32 v202, 0x358637bd
  v_mov_b32 v203, 0x358637bd
  v_mov_b32 v8, 0x3fb8aa3b
  s_waitcnt lgkmcnt(0)
  v_pk_add_f32 v[52:53], v[52:53], v[56:57]
  v_pk_add_f32 v[54:55], v[54:55], v[58:59]
  v_pk_mul_f32 v[60:61], v[36:37], v[8:9] op_sel:[0,0] op_sel_hi:[1,0]
  v_pk_mul_f32 v[62:63], v[38:39], v[8:9] op_sel:[0,0] op_sel_hi:[1,0]
  v_pk_mul_f32 v[64:65], v[40:41], v[8:9] op_sel:[0,0] op_sel_hi:[1,0]
  v_pk_mul_f32 v[66:67], v[42:43], v[8:9] op_sel:[0,0] op_sel_hi:[1,0]
  v_pk_mul_f32 v[68:69], v[44:45], v[8:9] op_sel:[0,0] op_sel_hi:[1,0]
  v_pk_mul_f32 v[70:71], v[46:47], v[8:9] op_sel:[0,0] op_sel_hi:[1,0]
  v_pk_mul_f32 v[72:73], v[48:49], v[8:9] op_sel:[0,0] op_sel_hi:[1,0]
  v_pk_mul_f32 v[74:75], v[50:51], v[8:9] op_sel:[0,0] op_sel_hi:[1,0]
  v_pk_fma_f32 v[132:133], v[20:21], v[52:53], v[132:133] op_sel:[0,0,0] op_sel_hi:[1,0,1]
  ds_read_b128 v[76:79], v242 offset:0
  s_add_u32 m0, s70, 52224
  v_pk_fma_f32 v[134:135], v[22:23], v[52:53], v[134:135] op_sel:[0,0,0] op_sel_hi:[1,0,1]
  v_pk_fma_f32 v[164:165], v[20:21], v[54:55], v[164:165] op_sel:[0,0,0] op_sel_hi:[1,0,1]
  v_pk_fma_f32 v[166:167], v[22:23], v[54:55], v[166:167] op_sel:[0,0,0] op_sel_hi:[1,0,1]
  ds_read_b128 v[84:87], v242 offset:768
  v_pk_mul_f32 v[204:205], v[132:133], v[60:61] op_sel:[0,0] op_sel_hi:[1,1]
  v_pk_mul_f32 v[206:207], v[134:135], v[62:63] op_sel:[0,0] op_sel_hi:[1,1]
  v_pk_mul_f32 v[164:165], v[164:165], v[36:37]
  ds_read_b128 v[80:83], v242 offset:64
  v_pk_mul_f32 v[166:167], v[166:167], v[38:39]
  s_add_u32 s4, s3, 24576
  v_exp_f32_e64 v204, v204 clamp
  v_exp_f32_e64 v206, v206 clamp
  v_exp_f32_e64 v205, v205 clamp
  ds_read_b128 v[88:91], v242 offset:832
  v_exp_f32_e64 v207, v207 clamp
  v_pk_fma_f32 v[132:133], v[132:133], v[36:37], v[200:201] op_sel:[0,0,0] op_sel_hi:[1,1,1]
  v_pk_fma_f32 v[134:135], v[134:135], v[38:39], v[200:201] op_sel:[0,0,0] op_sel_hi:[1,1,1]
  ds_read_b32 v92, v240 offset:0
  v_cvt_pk_bf16_f32 v220, v164, v165
  v_cvt_pk_bf16_f32 v221, v166, v167
  buffer_load_dwordx4 v10, s[40:43], s4 offen lds
  v_max_f32 v132, v132, v204
  ds_read_b32 v96, v240 offset:512
  v_max_f32 v134, v134, v206
  v_max_f32 v133, v133, v205
  v_max_f32 v135, v135, v207
  v_pk_add_f32 v[132:133], v[132:133], v[202:203]
  ds_read_b32 v93, v240 offset:64
  v_pk_add_f32 v[134:135], v[134:135], v[202:203]
  v_cvt_pk_bf16_f32 v212, v132, v133
  v_cvt_pk_bf16_f32 v213, v134, v135
  ds_read_b32 v97, v240 offset:576
  s_lshl_b32 s3, s11, 5
  v_pk_fma_f32 v[136:137], v[24:25], v[52:53], v[136:137] op_sel:[0,0,0] op_sel_hi:[1,0,1]
  v_pk_fma_f32 v[138:139], v[26:27], v[52:53], v[138:139] op_sel:[0,0,0] op_sel_hi:[1,0,1]
  v_pk_fma_f32 v[168:169], v[24:25], v[54:55], v[168:169] op_sel:[0,0,0] op_sel_hi:[1,0,1]
  ds_read_b32 v94, v241 offset:128
  v_pk_fma_f32 v[170:171], v[26:27], v[54:55], v[170:171] op_sel:[0,0,0] op_sel_hi:[1,0,1]
  v_pk_mul_f32 v[204:205], v[136:137], v[64:65] op_sel:[0,0] op_sel_hi:[1,1]
  v_pk_mul_f32 v[206:207], v[138:139], v[66:67] op_sel:[0,0] op_sel_hi:[1,1]
  v_pk_mul_f32 v[168:169], v[168:169], v[40:41]
  ds_read_b32 v98, v241 offset:640
  v_pk_mul_f32 v[170:171], v[170:171], v[42:43]
  s_add_u32 m0, s70, 139264
  v_exp_f32_e64 v204, v204 clamp
  v_exp_f32_e64 v206, v206 clamp
  ds_read_b32 v95, v241 offset:192
  v_exp_f32_e64 v205, v205 clamp
  v_exp_f32_e64 v207, v207 clamp
  v_pk_fma_f32 v[136:137], v[136:137], v[40:41], v[200:201] op_sel:[0,0,0] op_sel_hi:[1,1,1]
  ds_read_b32 v99, v241 offset:704
  v_pk_fma_f32 v[138:139], v[138:139], v[42:43], v[200:201] op_sel:[0,0,0] op_sel_hi:[1,1,1]
  v_cvt_pk_bf16_f32 v222, v168, v169
  s_add_u32 s4, s3, 0
  v_cvt_pk_bf16_f32 v223, v170, v171
  v_max_f32 v136, v136, v204
  v_max_f32 v138, v138, v206
  v_max_f32 v137, v137, v205
  v_max_f32 v139, v139, v207
  v_pk_add_f32 v[136:137], v[136:137], v[202:203]
  v_pk_add_f32 v[138:139], v[138:139], v[202:203]
  v_cvt_pk_bf16_f32 v214, v136, v137
  buffer_load_dwordx4 v10, s[40:43], s4 offen lds
  v_cvt_pk_bf16_f32 v215, v138, v139
  v_pk_fma_f32 v[140:141], v[28:29], v[52:53], v[140:141] op_sel:[0,0,0] op_sel_hi:[1,0,1]
  v_pk_fma_f32 v[142:143], v[30:31], v[52:53], v[142:143] op_sel:[0,0,0] op_sel_hi:[1,0,1]
  v_pk_fma_f32 v[172:173], v[28:29], v[54:55], v[172:173] op_sel:[0,0,0] op_sel_hi:[1,0,1]
  v_pk_fma_f32 v[174:175], v[30:31], v[54:55], v[174:175] op_sel:[0,0,0] op_sel_hi:[1,0,1]
  v_pk_mul_f32 v[204:205], v[140:141], v[68:69] op_sel:[0,0] op_sel_hi:[1,1]
  v_pk_mul_f32 v[206:207], v[142:143], v[70:71] op_sel:[0,0] op_sel_hi:[1,1]
  v_pk_mul_f32 v[172:173], v[172:173], v[44:45]
  s_add_u32 m0, s70, 140288
  v_pk_mul_f32 v[174:175], v[174:175], v[46:47]
  v_exp_f32_e64 v204, v204 clamp
  v_exp_f32_e64 v206, v206 clamp
  v_exp_f32_e64 v205, v205 clamp
  v_exp_f32_e64 v207, v207 clamp
  v_pk_fma_f32 v[140:141], v[140:141], v[44:45], v[200:201] op_sel:[0,0,0] op_sel_hi:[1,1,1]
  v_pk_fma_f32 v[142:143], v[142:143], v[46:47], v[200:201] op_sel:[0,0,0] op_sel_hi:[1,1,1]
  v_cvt_pk_bf16_f32 v224, v172, v173
  s_add_u32 s4, s3, 8192
  v_cvt_pk_bf16_f32 v225, v174, v175
  v_max_f32 v140, v140, v204
  v_max_f32 v142, v142, v206
  v_max_f32 v141, v141, v205
  v_max_f32 v143, v143, v207
  v_pk_add_f32 v[140:141], v[140:141], v[202:203]
  v_pk_add_f32 v[142:143], v[142:143], v[202:203]
  buffer_load_dwordx4 v10, s[40:43], s4 offen lds
  v_cvt_pk_bf16_f32 v216, v140, v141
  v_cvt_pk_bf16_f32 v217, v142, v143
  v_pk_fma_f32 v[144:145], v[32:33], v[52:53], v[144:145] op_sel:[0,0,0] op_sel_hi:[1,0,1]
  v_pk_fma_f32 v[146:147], v[34:35], v[52:53], v[146:147] op_sel:[0,0,0] op_sel_hi:[1,0,1]
  v_pk_fma_f32 v[176:177], v[32:33], v[54:55], v[176:177] op_sel:[0,0,0] op_sel_hi:[1,0,1]
  v_pk_fma_f32 v[178:179], v[34:35], v[54:55], v[178:179] op_sel:[0,0,0] op_sel_hi:[1,0,1]
  v_pk_mul_f32 v[204:205], v[144:145], v[72:73] op_sel:[0,0] op_sel_hi:[1,1]
  v_pk_mul_f32 v[206:207], v[146:147], v[74:75] op_sel:[0,0] op_sel_hi:[1,1]
  s_add_u32 m0, s70, 141312
  v_pk_mul_f32 v[176:177], v[176:177], v[48:49]
  v_pk_mul_f32 v[178:179], v[178:179], v[50:51]
  v_exp_f32_e64 v204, v204 clamp
  v_exp_f32_e64 v206, v206 clamp
  v_exp_f32_e64 v205, v205 clamp
  v_exp_f32_e64 v207, v207 clamp
  v_pk_fma_f32 v[144:145], v[144:145], v[48:49], v[200:201] op_sel:[0,0,0] op_sel_hi:[1,1,1]
  v_pk_fma_f32 v[146:147], v[146:147], v[50:51], v[200:201] op_sel:[0,0,0] op_sel_hi:[1,1,1]
  s_add_u32 s4, s3, 16384
  v_cvt_pk_bf16_f32 v226, v176, v177
  v_cvt_pk_bf16_f32 v227, v178, v179
  v_max_f32 v144, v144, v204
  v_max_f32 v146, v146, v206
  v_max_f32 v145, v145, v205
  v_max_f32 v147, v147, v207
  v_pk_add_f32 v[144:145], v[144:145], v[202:203]
  v_pk_add_f32 v[146:147], v[146:147], v[202:203]
  buffer_load_dwordx4 v10, s[40:43], s4 offen lds
  v_cvt_pk_bf16_f32 v218, v144, v145
  v_cvt_pk_bf16_f32 v219, v146, v147
  s_nop 1
  v_mfma_f32_16x16x32_bf16 v[228:231], v[212:215], v[220:223], 0
  v_mfma_f32_16x16x32_bf16 v[4:7], v[16:19], v[212:215], 0
  v_mfma_f32_16x16x32_bf16 v[228:231], v[216:219], v[224:227], v[228:231]
  v_mfma_f32_16x16x32_bf16 v[4:7], v[16:19], v[216:219], v[4:7]
  v_pk_fma_f32 v[148:149], v[20:21], v[52:53], v[148:149] op_sel:[0,1,0] op_sel_hi:[1,1,1]
  s_add_u32 m0, s70, 142336
  v_pk_fma_f32 v[150:151], v[22:23], v[52:53], v[150:151] op_sel:[0,1,0] op_sel_hi:[1,1,1]
  v_pk_fma_f32 v[180:181], v[20:21], v[54:55], v[180:181] op_sel:[0,1,0] op_sel_hi:[1,1,1]
  v_pk_fma_f32 v[182:183], v[22:23], v[54:55], v[182:183] op_sel:[0,1,0] op_sel_hi:[1,1,1]
  v_pk_mul_f32 v[204:205], v[148:149], v[60:61] op_sel:[0,0] op_sel_hi:[1,1]
  v_pk_mul_f32 v[206:207], v[150:151], v[62:63] op_sel:[0,0] op_sel_hi:[1,1]
  v_pk_mul_f32 v[180:181], v[180:181], v[36:37]
  v_pk_mul_f32 v[182:183], v[182:183], v[38:39]
  s_add_u32 s4, s3, 24576
  v_exp_f32_e64 v204, v204 clamp
  v_exp_f32_e64 v206, v206 clamp
  v_exp_f32_e64 v205, v205 clamp
  v_exp_f32_e64 v207, v207 clamp
  v_pk_fma_f32 v[148:149], v[148:149], v[36:37], v[200:201] op_sel:[0,0,0] op_sel_hi:[1,1,1]
  v_pk_fma_f32 v[150:151], v[150:151], v[38:39], v[200:201] op_sel:[0,0,0] op_sel_hi:[1,1,1]
  v_cvt_pk_bf16_f32 v220, v180, v181
  v_cvt_pk_bf16_f32 v221, v182, v183
  buffer_load_dwordx4 v10, s[40:43], s4 offen lds
  v_max_f32 v148, v148, v204
  v_max_f32 v150, v150, v206
  v_max_f32 v149, v149, v205
  v_max_f32 v151, v151, v207
  v_pk_add_f32 v[148:149], v[148:149], v[202:203]
  v_pk_add_f32 v[150:151], v[150:151], v[202:203]
  v_cvt_pk_bf16_f32 v212, v148, v149
  v_cvt_pk_bf16_f32 v213, v150, v151
  s_lshl_b32 s3, s17, 5
  v_pk_fma_f32 v[152:153], v[24:25], v[52:53], v[152:153] op_sel:[0,1,0] op_sel_hi:[1,1,1]
  v_pk_fma_f32 v[154:155], v[26:27], v[52:53], v[154:155] op_sel:[0,1,0] op_sel_hi:[1,1,1]
  v_pk_fma_f32 v[184:185], v[24:25], v[54:55], v[184:185] op_sel:[0,1,0] op_sel_hi:[1,1,1]
  v_pk_fma_f32 v[186:187], v[26:27], v[54:55], v[186:187] op_sel:[0,1,0] op_sel_hi:[1,1,1]
  v_pk_mul_f32 v[204:205], v[152:153], v[64:65] op_sel:[0,0] op_sel_hi:[1,1]
  v_pk_mul_f32 v[206:207], v[154:155], v[66:67] op_sel:[0,0] op_sel_hi:[1,1]
  v_pk_mul_f32 v[184:185], v[184:185], v[40:41]
  v_pk_mul_f32 v[186:187], v[186:187], v[42:43]
  s_add_u32 m0, s70, 16384
  s_add_u32 s4, s3, 0
  buffer_load_dwordx4 v10, s[44:47], s4 offen lds
  v_exp_f32_e64 v204, v204 clamp
  v_exp_f32_e64 v206, v206 clamp
  v_exp_f32_e64 v205, v205 clamp
  v_exp_f32_e64 v207, v207 clamp
  v_pk_fma_f32 v[152:153], v[152:153], v[40:41], v[200:201] op_sel:[0,0,0] op_sel_hi:[1,1,1]
  v_pk_fma_f32 v[154:155], v[154:155], v[42:43], v[200:201] op_sel:[0,0,0] op_sel_hi:[1,1,1]
  v_cvt_pk_bf16_f32 v222, v184, v185
  s_add_u32 m0, s70, 17408
  s_add_u32 s4, s3, 8192
  buffer_load_dwordx4 v10, s[44:47], s4 offen lds
  v_cvt_pk_bf16_f32 v223, v186, v187
  v_max_f32 v152, v152, v204
  v_max_f32 v154, v154, v206
  v_max_f32 v153, v153, v205
  v_max_f32 v155, v155, v207
  v_pk_add_f32 v[152:153], v[152:153], v[202:203]
  v_pk_add_f32 v[154:155], v[154:155], v[202:203]
  v_cvt_pk_bf16_f32 v214, v152, v153
  s_add_u32 m0, s70, 18432
  s_add_u32 s4, s3, 16384
  buffer_load_dwordx4 v10, s[44:47], s4 offen lds
  v_cvt_pk_bf16_f32 v215, v154, v155
  v_pk_fma_f32 v[156:157], v[28:29], v[52:53], v[156:157] op_sel:[0,1,0] op_sel_hi:[1,1,1]
  v_pk_fma_f32 v[158:159], v[30:31], v[52:53], v[158:159] op_sel:[0,1,0] op_sel_hi:[1,1,1]
  v_pk_fma_f32 v[188:189], v[28:29], v[54:55], v[188:189] op_sel:[0,1,0] op_sel_hi:[1,1,1]
  v_pk_fma_f32 v[190:191], v[30:31], v[54:55], v[190:191] op_sel:[0,1,0] op_sel_hi:[1,1,1]
  v_pk_mul_f32 v[204:205], v[156:157], v[68:69] op_sel:[0,0] op_sel_hi:[1,1]
  v_pk_mul_f32 v[206:207], v[158:159], v[70:71] op_sel:[0,0] op_sel_hi:[1,1]
  v_pk_mul_f32 v[188:189], v[188:189], v[44:45]
  s_add_u32 m0, s70, 19456
  s_add_u32 s4, s3, 24576
  buffer_load_dwordx4 v10, s[44:47], s4 offen lds
  v_pk_mul_f32 v[190:191], v[190:191], v[46:47]
  v_exp_f32_e64 v204, v204 clamp
  v_exp_f32_e64 v206, v206 clamp
  v_exp_f32_e64 v205, v205 clamp
  v_exp_f32_e64 v207, v207 clamp
  v_pk_fma_f32 v[156:157], v[156:157], v[44:45], v[200:201] op_sel:[0,0,0] op_sel_hi:[1,1,1]
  v_pk_fma_f32 v[158:159], v[158:159], v[46:47], v[200:201] op_sel:[0,0,0] op_sel_hi:[1,1,1]
  v_cvt_pk_bf16_f32 v224, v188, v189
  s_lshl_b32 s3, s12, 5
  v_cvt_pk_bf16_f32 v225, v190, v191
  v_max_f32 v156, v156, v204
  v_max_f32 v158, v158, v206
  v_max_f32 v157, v157, v205
  v_max_f32 v159, v159, v207
  v_pk_add_f32 v[156:157], v[156:157], v[202:203]
  v_pk_add_f32 v[158:159], v[158:159], v[202:203]
  s_add_u32 m0, s70, 65536
  s_add_u32 s4, s3, 0
  buffer_load_dwordx4 v10, s[40:43], s4 offen lds
  v_cvt_pk_bf16_f32 v216, v156, v157
  v_cvt_pk_bf16_f32 v217, v158, v159
  v_pk_fma_f32 v[160:161], v[32:33], v[52:53], v[160:161] op_sel:[0,1,0] op_sel_hi:[1,1,1]
  v_pk_fma_f32 v[162:163], v[34:35], v[52:53], v[162:163] op_sel:[0,1,0] op_sel_hi:[1,1,1]
  v_pk_fma_f32 v[192:193], v[32:33], v[54:55], v[192:193] op_sel:[0,1,0] op_sel_hi:[1,1,1]
  v_pk_fma_f32 v[194:195], v[34:35], v[54:55], v[194:195] op_sel:[0,1,0] op_sel_hi:[1,1,1]
  v_pk_mul_f32 v[204:205], v[160:161], v[72:73] op_sel:[0,0] op_sel_hi:[1,1]
  v_pk_mul_f32 v[206:207], v[162:163], v[74:75] op_sel:[0,0] op_sel_hi:[1,1]
  s_add_u32 m0, s70, 66560
  s_add_u32 s4, s3, 8192
  buffer_load_dwordx4 v10, s[40:43], s4 offen lds
  v_pk_mul_f32 v[192:193], v[192:193], v[48:49]
  v_pk_mul_f32 v[194:195], v[194:195], v[50:51]
  v_exp_f32_e64 v204, v204 clamp
  v_exp_f32_e64 v206, v206 clamp
  v_exp_f32_e64 v205, v205 clamp
  v_exp_f32_e64 v207, v207 clamp
  v_pk_fma_f32 v[160:161], v[160:161], v[48:49], v[200:201] op_sel:[0,0,0] op_sel_hi:[1,1,1]
  v_pk_fma_f32 v[162:163], v[162:163], v[50:51], v[200:201] op_sel:[0,0,0] op_sel_hi:[1,1,1]
  s_add_u32 m0, s70, 67584
  s_add_u32 s4, s3, 16384
  buffer_load_dwordx4 v10, s[40:43], s4 offen lds
  v_cvt_pk_bf16_f32 v226, v192, v193
  v_cvt_pk_bf16_f32 v227, v194, v195
  v_max_f32 v160, v160, v204
  v_max_f32 v162, v162, v206
  v_max_f32 v161, v161, v205
  v_max_f32 v163, v163, v207
  v_pk_add_f32 v[160:161], v[160:161], v[202:203]
  v_pk_add_f32 v[162:163], v[162:163], v[202:203]
  s_add_u32 m0, s70, 68608
  s_add_u32 s4, s3, 24576
  buffer_load_dwordx4 v10, s[40:43], s4 offen lds
  v_cvt_pk_bf16_f32 v218, v160, v161
  v_cvt_pk_bf16_f32 v219, v162, v163
  s_nop 1
  v_mfma_f32_16x16x32_bf16 v[232:235], v[212:215], v[220:223], 0
  v_mfma_f32_16x16x32_bf16 v[208:211], v[16:19], v[212:215], 0
  v_mfma_f32_16x16x32_bf16 v[232:235], v[216:219], v[224:227], v[232:235]
  v_mfma_f32_16x16x32_bf16 v[208:211], v[16:19], v[216:219], v[208:211]
  s_cmp_eq_u32 s25, 0
  s_cselect_b64 vcc, -1, 0
  v_lshl_add_u32 v2, v239, 2, s68
  v_lshl_add_u32 v3, v239, 2, s69
  v_add_u32 v9, s68, v239
  v_add_u32 v247, s69, v239
  s_waitcnt lgkmcnt(0)
  v_pk_add_f32 v[76:77], v[76:77], v[84:85]
  v_pk_add_f32 v[78:79], v[78:79], v[86:87]
  v_pk_add_f32 v[80:81], v[80:81], v[88:89]
  v_pk_add_f32 v[82:83], v[82:83], v[90:91]
  v_cndmask_b32 v212, v228, v232, vcc
  v_cndmask_b32 v213, v229, v233, vcc
  v_cndmask_b32 v214, v230, v234, vcc
  v_cndmask_b32 v215, v231, v235, vcc
  v_cndmask_b32 v216, v4, v208, vcc
  ds_write_b128 v2, v[212:215]
  ds_write_b32 v9, v216 offset:1024
  v_cndmask_b32 v228, v232, v228, vcc
  v_cndmask_b32 v229, v233, v229, vcc
  v_cndmask_b32 v230, v234, v230, vcc
  v_cndmask_b32 v231, v235, v231, vcc
  v_cndmask_b32 v4, v208, v4, vcc
  v_pk_mul_f32 v[196:197], v[96:97], v[8:9] op_sel:[0,0] op_sel_hi:[1,0]
  v_pk_mul_f32 v[198:199], v[98:99], v[8:9] op_sel:[0,0] op_sel_hi:[1,0]
  v_cmp_gt_u32 vcc, 16, v1
  v_mov_b32 v9, 0x7ffffff0
  s_waitcnt lgkmcnt(0)
  s_barrier
  ds_read_b128 v[232:235], v3
  ds_read_b32 v208, v247 offset:1024
  v_cndmask_b32 v9, v9, v239, vcc
  v_pk_fma_f32 v[100:101], v[76:77], v[92:93], v[100:101] op_sel:[0,0,0] op_sel_hi:[1,0,1]
  v_pk_fma_f32 v[102:103], v[78:79], v[92:93], v[102:103] op_sel:[0,0,0] op_sel_hi:[1,0,1]
  v_pk_fma_f32 v[116:117], v[80:81], v[92:93], v[116:117] op_sel:[0,0,0] op_sel_hi:[1,0,1]
  v_pk_fma_f32 v[118:119], v[82:83], v[92:93], v[118:119] op_sel:[0,0,0] op_sel_hi:[1,0,1]
  v_pk_mul_f32 v[218:219], v[100:101], v[196:197] op_sel:[0,0] op_sel_hi:[1,0]
  v_pk_mul_f32 v[220:221], v[102:103], v[196:197] op_sel:[0,0] op_sel_hi:[1,0]
  v_pk_mul_f32 v[222:223], v[116:117], v[196:197] op_sel:[0,0] op_sel_hi:[1,0]
  v_pk_mul_f32 v[224:225], v[118:119], v[196:197] op_sel:[0,0] op_sel_hi:[1,0]
  v_exp_f32_e64 v218, v218 clamp
  v_exp_f32_e64 v220, v220 clamp
  v_exp_f32_e64 v222, v222 clamp
  v_exp_f32_e64 v224, v224 clamp
  v_exp_f32_e64 v219, v219 clamp
  v_exp_f32_e64 v221, v221 clamp
  v_exp_f32_e64 v223, v223 clamp
  v_exp_f32_e64 v225, v225 clamp
  v_pk_fma_f32 v[100:101], v[100:101], v[96:97], v[200:201] op_sel:[0,0,0] op_sel_hi:[1,0,1]
  v_pk_fma_f32 v[102:103], v[102:103], v[96:97], v[200:201] op_sel:[0,0,0] op_sel_hi:[1,0,1]
  s_waitcnt lgkmcnt(0)
  v_pk_add_f32 v[228:229], v[228:229], v[232:233]
  v_pk_add_f32 v[230:231], v[230:231], v[234:235]
  v_add_f32 v4, v4, v208
  ds_write_b128 v3, v[228:231]
  ds_read_b32 v232, v247 offset:0
  ds_read_b32 v233, v247 offset:256
  ds_read_b32 v234, v247 offset:512
  ds_read_b32 v235, v247 offset:768
  v_pk_fma_f32 v[116:117], v[116:117], v[96:97], v[200:201] op_sel:[0,0,0] op_sel_hi:[1,0,1]
  v_pk_fma_f32 v[118:119], v[118:119], v[96:97], v[200:201] op_sel:[0,0,0] op_sel_hi:[1,0,1]
  v_max_f32 v100, v100, v218
  v_max_f32 v102, v102, v220
  v_max_f32 v116, v116, v222
  v_max_f32 v118, v118, v224
  v_max_f32 v101, v101, v219
  v_max_f32 v103, v103, v221
  v_max_f32 v117, v117, v223
  v_max_f32 v119, v119, v225
  v_pk_add_f32 v[100:101], v[100:101], v[202:203]
  v_pk_add_f32 v[102:103], v[102:103], v[202:203]
  v_pk_add_f32 v[116:117], v[116:117], v[202:203]
  v_pk_add_f32 v[118:119], v[118:119], v[202:203]
  v_cvt_pk_bf16_f32 v20, v100, v101
  v_cvt_pk_bf16_f32 v21, v102, v103
  v_cvt_pk_bf16_f32 v22, v116, v117
  v_cvt_pk_bf16_f32 v23, v118, v119
  buffer_store_dwordx4 v[20:23], v238, s[36:39], s84 offen sc1
  s_waitcnt vmcnt(17)
  s_mov_b32 s71, 0
L_init_top_19:
  v_cmp_ne_u32 vcc, 1, v254
  s_cbranch_vccz L_init_ok_20
  s_sleep 4
  buffer_load_dword v254, v252, s[52:55], 8 offen sc1
  s_add_u32 s71, s71, 1
  s_cmp_lt_u32 s71, 0x20000
  s_waitcnt vmcnt(0)
  s_cbranch_scc1 L_init_top_19
L_init_ok_20:
  s_waitcnt lgkmcnt(0)
  v_pk_fma_f32 v[104:105], v[76:77], v[92:93], v[104:105] op_sel:[0,1,0] op_sel_hi:[1,1,1]
  buffer_atomic_add_f32 v232, v239, s[36:39], s88 offen offset:0
  v_pk_fma_f32 v[106:107], v[78:79], v[92:93], v[106:107] op_sel:[0,1,0] op_sel_hi:[1,1,1]
  v_pk_fma_f32 v[120:121], v[80:81], v[92:93], v[120:121] op_sel:[0,1,0] op_sel_hi:[1,1,1]
  v_pk_fma_f32 v[122:123], v[82:83], v[92:93], v[122:123] op_sel:[0,1,0] op_sel_hi:[1,1,1]
  v_pk_mul_f32 v[218:219], v[104:105], v[196:197] op_sel:[0,1] op_sel_hi:[1,1]
  v_pk_mul_f32 v[220:221], v[106:107], v[196:197] op_sel:[0,1] op_sel_hi:[1,1]
  v_pk_mul_f32 v[222:223], v[120:121], v[196:197] op_sel:[0,1] op_sel_hi:[1,1]
  buffer_atomic_add_f32 v233, v239, s[36:39], s88 offen offset:256
  v_pk_mul_f32 v[224:225], v[122:123], v[196:197] op_sel:[0,1] op_sel_hi:[1,1]
  v_exp_f32_e64 v218, v218 clamp
  v_exp_f32_e64 v220, v220 clamp
  v_exp_f32_e64 v222, v222 clamp
  v_exp_f32_e64 v224, v224 clamp
  v_exp_f32_e64 v219, v219 clamp
  v_exp_f32_e64 v221, v221 clamp
  buffer_atomic_add_f32 v234, v239, s[36:39], s88 offen offset:512
  v_exp_f32_e64 v223, v223 clamp
  v_exp_f32_e64 v225, v225 clamp
  v_pk_fma_f32 v[104:105], v[104:105], v[96:97], v[200:201] op_sel:[0,1,0] op_sel_hi:[1,1,1]
  v_pk_fma_f32 v[106:107], v[106:107], v[96:97], v[200:201] op_sel:[0,1,0] op_sel_hi:[1,1,1]
  v_pk_fma_f32 v[120:121], v[120:121], v[96:97], v[200:201] op_sel:[0,1,0] op_sel_hi:[1,1,1]
  v_pk_fma_f32 v[122:123], v[122:123], v[96:97], v[200:201] op_sel:[0,1,0] op_sel_hi:[1,1,1]
  buffer_atomic_add_f32 v235, v239, s[36:39], s88 offen offset:768
  v_max_f32 v104, v104, v218
  v_max_f32 v106, v106, v220
  v_max_f32 v120, v120, v222
  v_max_f32 v122, v122, v224
  v_max_f32 v105, v105, v219
  v_max_f32 v107, v107, v221
  v_max_f32 v121, v121, v223
  buffer_atomic_add_f32 v4, v9, s[36:39], s89 offen
  v_max_f32 v123, v123, v225
  v_pk_add_f32 v[104:105], v[104:105], v[202:203]
  v_pk_add_f32 v[106:107], v[106:107], v[202:203]
  v_pk_add_f32 v[120:121], v[120:121], v[202:203]
  v_pk_add_f32 v[122:123], v[122:123], v[202:203]
  v_cvt_pk_bf16_f32 v24, v104, v105
  v_cvt_pk_bf16_f32 v25, v106, v107
  v_cvt_pk_bf16_f32 v26, v120, v121
  v_cvt_pk_bf16_f32 v27, v122, v123
  buffer_store_dwordx4 v[24:27], v238, s[36:39], s85 offen sc1
  v_pk_fma_f32 v[108:109], v[76:77], v[94:95], v[108:109] op_sel:[0,0,0] op_sel_hi:[1,0,1]
  v_pk_fma_f32 v[110:111], v[78:79], v[94:95], v[110:111] op_sel:[0,0,0] op_sel_hi:[1,0,1]
  v_pk_fma_f32 v[124:125], v[80:81], v[94:95], v[124:125] op_sel:[0,0,0] op_sel_hi:[1,0,1]
  v_pk_fma_f32 v[126:127], v[82:83], v[94:95], v[126:127] op_sel:[0,0,0] op_sel_hi:[1,0,1]
  v_pk_mul_f32 v[218:219], v[108:109], v[198:199] op_sel:[0,0] op_sel_hi:[1,0]
  v_pk_mul_f32 v[220:221], v[110:111], v[198:199] op_sel:[0,0] op_sel_hi:[1,0]
  v_pk_mul_f32 v[222:223], v[124:125], v[198:199] op_sel:[0,0] op_sel_hi:[1,0]
  v_pk_mul_f32 v[224:225], v[126:127], v[198:199] op_sel:[0,0] op_sel_hi:[1,0]
  v_exp_f32_e64 v218, v218 clamp
  v_exp_f32_e64 v220, v220 clamp
  v_exp_f32_e64 v222, v222 clamp
  v_exp_f32_e64 v224, v224 clamp
  v_exp_f32_e64 v219, v219 clamp
  v_exp_f32_e64 v221, v221 clamp
  v_exp_f32_e64 v223, v223 clamp
  v_exp_f32_e64 v225, v225 clamp
  v_pk_fma_f32 v[108:109], v[108:109], v[98:99], v[200:201] op_sel:[0,0,0] op_sel_hi:[1,0,1]
  v_pk_fma_f32 v[110:111], v[110:111], v[98:99], v[200:201] op_sel:[0,0,0] op_sel_hi:[1,0,1]
  v_pk_fma_f32 v[124:125], v[124:125], v[98:99], v[200:201] op_sel:[0,0,0] op_sel_hi:[1,0,1]
  v_pk_fma_f32 v[126:127], v[126:127], v[98:99], v[200:201] op_sel:[0,0,0] op_sel_hi:[1,0,1]
  v_max_f32 v108, v108, v218
  v_max_f32 v110, v110, v220
  v_max_f32 v124, v124, v222
  v_max_f32 v126, v126, v224
  v_max_f32 v109, v109, v219
  v_max_f32 v111, v111, v221
  v_max_f32 v125, v125, v223
  v_max_f32 v127, v127, v225
  v_pk_add_f32 v[108:109], v[108:109], v[202:203]
  v_pk_add_f32 v[110:111], v[110:111], v[202:203]
  v_pk_add_f32 v[124:125], v[124:125], v[202:203]
  v_pk_add_f32 v[126:127], v[126:127], v[202:203]
  v_cvt_pk_bf16_f32 v28, v108, v109
  v_cvt_pk_bf16_f32 v29, v110, v111
  v_cvt_pk_bf16_f32 v30, v124, v125
  v_cvt_pk_bf16_f32 v31, v126, v127
  buffer_store_dwordx4 v[28:31], v238, s[36:39], s86 offen sc1
  v_pk_fma_f32 v[112:113], v[76:77], v[94:95], v[112:113] op_sel:[0,1,0] op_sel_hi:[1,1,1]
  v_pk_fma_f32 v[114:115], v[78:79], v[94:95], v[114:115] op_sel:[0,1,0] op_sel_hi:[1,1,1]
  v_pk_fma_f32 v[128:129], v[80:81], v[94:95], v[128:129] op_sel:[0,1,0] op_sel_hi:[1,1,1]
  v_pk_fma_f32 v[130:131], v[82:83], v[94:95], v[130:131] op_sel:[0,1,0] op_sel_hi:[1,1,1]
  v_pk_mul_f32 v[218:219], v[112:113], v[198:199] op_sel:[0,1] op_sel_hi:[1,1]
  v_pk_mul_f32 v[220:221], v[114:115], v[198:199] op_sel:[0,1] op_sel_hi:[1,1]
  v_pk_mul_f32 v[222:223], v[128:129], v[198:199] op_sel:[0,1] op_sel_hi:[1,1]
  v_pk_mul_f32 v[224:225], v[130:131], v[198:199] op_sel:[0,1] op_sel_hi:[1,1]
  v_exp_f32_e64 v218, v218 clamp
  v_exp_f32_e64 v220, v220 clamp
  v_exp_f32_e64 v222, v222 clamp
  v_exp_f32_e64 v224, v224 clamp
  v_exp_f32_e64 v219, v219 clamp
  v_exp_f32_e64 v221, v221 clamp
  v_exp_f32_e64 v223, v223 clamp
  v_exp_f32_e64 v225, v225 clamp
  v_pk_fma_f32 v[112:113], v[112:113], v[98:99], v[200:201] op_sel:[0,1,0] op_sel_hi:[1,1,1]
  v_pk_fma_f32 v[114:115], v[114:115], v[98:99], v[200:201] op_sel:[0,1,0] op_sel_hi:[1,1,1]
  v_pk_fma_f32 v[128:129], v[128:129], v[98:99], v[200:201] op_sel:[0,1,0] op_sel_hi:[1,1,1]
  v_pk_fma_f32 v[130:131], v[130:131], v[98:99], v[200:201] op_sel:[0,1,0] op_sel_hi:[1,1,1]
  v_max_f32 v112, v112, v218
  v_max_f32 v114, v114, v220
  v_max_f32 v128, v128, v222
  v_max_f32 v130, v130, v224
  v_max_f32 v113, v113, v219
  v_max_f32 v115, v115, v221
  v_max_f32 v129, v129, v223
  v_max_f32 v131, v131, v225
  v_pk_add_f32 v[112:113], v[112:113], v[202:203]
  v_pk_add_f32 v[114:115], v[114:115], v[202:203]
  v_pk_add_f32 v[128:129], v[128:129], v[202:203]
  v_pk_add_f32 v[130:131], v[130:131], v[202:203]
  v_cvt_pk_bf16_f32 v32, v112, v113
  v_cvt_pk_bf16_f32 v33, v114, v115
  v_cvt_pk_bf16_f32 v34, v128, v129
  v_cvt_pk_bf16_f32 v35, v130, v131
  buffer_store_dwordx4 v[32:35], v238, s[36:39], s87 offen sc1
  v_and_b32 v5, 7, v1
  v_lshlrev_b32 v5, 7, v5
  v_and_b32 v6, 31, v1
  v_lshlrev_b32 v6, 7, v6
  v_lshrrev_b32 v13, 4, v1
  v_lshlrev_b32 v13, 4, v13
  v_and_b32 v14, 1, v1
  v_lshl_add_u32 v13, v14, 6, v13
  ds_read_b64_tr_b16 a[16:17], v11 offset:32768
  ds_read_b64_tr_b16 a[18:19], v11 offset:34816
  ds_read_b64_tr_b16 a[20:21], v12 offset:32768
  ds_read_b64_tr_b16 a[22:23], v12 offset:34816
  ds_read_b64_tr_b16 a[24:25], v11 offset:33280
  ds_read_b64_tr_b16 a[26:27], v11 offset:35328
  ds_read_b64_tr_b16 a[28:29], v12 offset:33280
  ds_read_b64_tr_b16 a[30:31], v12 offset:35328
  v_add_u32 v250, 98304, v11
  v_add_u32 v251, 98304, v12
  ds_read_b64_tr_b16 a[32:33], v250 offset:0
  ds_read_b64_tr_b16 a[34:35], v250 offset:2048
  ds_read_b64_tr_b16 a[36:37], v251 offset:0
  ds_read_b64_tr_b16 a[38:39], v251 offset:2048
  ds_read_b64_tr_b16 a[40:41], v250 offset:512
  ds_read_b64_tr_b16 a[42:43], v250 offset:2560
  ds_read_b64_tr_b16 a[44:45], v251 offset:512
  ds_read_b64_tr_b16 a[46:47], v251 offset:2560
  ds_read_b64_tr_b16 a[48:49], v11 offset:0
  ds_read_b64_tr_b16 a[50:51], v11 offset:2048
  ds_read_b64_tr_b16 a[52:53], v12 offset:0
  ds_read_b64_tr_b16 a[54:55], v12 offset:2048
  ds_read_b64_tr_b16 a[56:57], v11 offset:512
  ds_read_b64_tr_b16 a[58:59], v11 offset:2560
  ds_read_b64_tr_b16 a[60:61], v12 offset:512
  ds_read_b64_tr_b16 a[62:63], v12 offset:2560
  v_add_u32 v250, 122880, v11
  v_add_u32 v251, 122880, v12
  ds_read_b64_tr_b16 a[64:65], v250 offset:0
  ds_read_b64_tr_b16 a[66:67], v250 offset:2048
  ds_read_b64_tr_b16 a[68:69], v251 offset:0
  ds_read_b64_tr_b16 a[70:71], v251 offset:2048
  ds_read_b64_tr_b16 a[72:73], v250 offset:512
  ds_read_b64_tr_b16 a[74:75], v250 offset:2560
  ds_read_b64_tr_b16 a[76:77], v251 offset:512
  ds_read_b64_tr_b16 a[78:79], v251 offset:2560
  v_mov_b32 v7, 1
  v_mov_b32 v14, 0
  s_waitcnt vmcnt(0) lgkmcnt(0)
  s_barrier
  s_cmp_lg_u32 s24, 0
  s_cbranch_scc1 L_pub_21
  buffer_store_dword v7, v14, s[36:39], s0 offen sc1
L_pub_21:
  s_lshl_b32 s3, s13, 5
  s_add_u32 m0, s70, 81920
  s_add_u32 s4, s3, 0
  buffer_load_dwordx4 v10, s[40:43], s4 offen lds
  s_add_u32 m0, s70, 82944
  s_add_u32 s4, s3, 8192
  buffer_load_dwordx4 v10, s[40:43], s4 offen lds
  s_add_u32 m0, s70, 83968
  s_add_u32 s4, s3, 16384
  buffer_load_dwordx4 v10, s[40:43], s4 offen lds
  s_add_u32 m0, s70, 84992
  s_add_u32 s4, s3, 24576
  buffer_load_dwordx4 v10, s[40:43], s4 offen lds
  s_lshl_b32 s3, s18, 5
  s_add_u32 m0, s70, 32768
  s_add_u32 s4, s3, 0
  buffer_load_dwordx4 v10, s[44:47], s4 offen lds
  s_add_u32 m0, s70, 33792
  s_add_u32 s4, s3, 8192
  buffer_load_dwordx4 v10, s[44:47], s4 offen lds
  s_add_u32 m0, s70, 34816
  s_add_u32 s4, s3, 16384
  buffer_load_dwordx4 v10, s[44:47], s4 offen lds
  s_add_u32 m0, s70, 35840
  s_add_u32 s4, s3, 24576
  buffer_load_dwordx4 v10, s[44:47], s4 offen lds
  s_cmp_lg_u32 s24, 0
  s_cbranch_scc1 L_poll_22
  buffer_load_dword v7, v5, s[36:39], s90 offen sc1
L_poll_22:
  s_lshl_b32 s3, s14, 5
  s_add_u32 m0, s70, 98304
  s_add_u32 s4, s3, 0
  buffer_load_dwordx4 v10, s[40:43], s4 offen lds
  s_add_u32 m0, s70, 99328
  s_add_u32 s4, s3, 8192
  buffer_load_dwordx4 v10, s[40:43], s4 offen lds
  s_add_u32 m0, s70, 100352
  s_add_u32 s4, s3, 16384
  buffer_load_dwordx4 v10, s[40:43], s4 offen lds
  s_add_u32 m0, s70, 101376
  s_add_u32 s4, s3, 24576
  buffer_load_dwordx4 v10, s[40:43], s4 offen lds
  s_lshl_b32 s3, s15, 5
  s_add_u32 m0, s70, 0
  s_add_u32 s4, s3, 0
  buffer_load_dwordx4 v10, s[40:43], s4 offen lds
  s_add_u32 m0, s70, 1024
  s_add_u32 s4, s3, 8192
  buffer_load_dwordx4 v10, s[40:43], s4 offen lds
  s_add_u32 m0, s70, 2048
  s_add_u32 s4, s3, 16384
  buffer_load_dwordx4 v10, s[40:43], s4 offen lds
  s_add_u32 m0, s70, 3072
  s_add_u32 s4, s3, 24576
  buffer_load_dwordx4 v10, s[40:43], s4 offen lds
  s_lshl_b32 s3, s19, 5
  s_add_u32 m0, s70, 122880
  s_add_u32 s4, s3, 0
  buffer_load_dwordx4 v10, s[44:47], s4 offen lds
  s_add_u32 m0, s70, 123904
  s_add_u32 s4, s3, 8192
  buffer_load_dwordx4 v10, s[44:47], s4 offen lds
  s_add_u32 m0, s70, 124928
  s_add_u32 s4, s3, 16384
  buffer_load_dwordx4 v10, s[44:47], s4 offen lds
  s_add_u32 m0, s70, 125952
  s_add_u32 s4, s3, 24576
  buffer_load_dwordx4 v10, s[44:47], s4 offen lds
  s_min_u32 s5, s5, 43008
  s_add_u32 s5, s5, s92
  s_min_u32 s6, s6, 43008
  s_add_u32 s6, s6, s92
  s_min_u32 s7, s7, 43008
  s_add_u32 s7, s7, s92
  s_min_u32 s8, s8, 43008
  s_add_u32 s8, s8, s92
  s_min_u32 s9, s9, 43008
  s_add_u32 s9, s9, s92
  s_min_u32 s10, s10, 43008
  s_add_u32 s10, s10, s92
  s_min_u32 s11, s11, 43008
  s_add_u32 s11, s11, s92
  s_min_u32 s12, s12, 43008
  s_add_u32 s12, s12, s92
  s_min_u32 s13, s13, 43008
  s_add_u32 s13, s13, s92
  s_min_u32 s14, s14, 43008
  s_add_u32 s14, s14, s92
  s_min_u32 s15, s15, 43008
  s_add_u32 s15, s15, s92
  s_waitcnt vmcnt(12)
  s_branch L_p2
L_ffn:
  v_mfma_f32_16x16x32_bf16 v[100:103], v[36:39], v[20:23], 0
  ds_read_b128 v[60:63], v4 offset:512
  s_add_u32 m0, s27, 32768
  v_mfma_f32_16x16x32_bf16 v[104:107], v[36:39], v[24:27], 0
  ds_read_b64_tr_b16 v[76:77], v6 offset:4096
  s_add_u32 s4, s21, 0
  v_mfma_f32_16x16x32_bf16 v[108:111], v[36:39], v[28:31], 0
  ds_read_b64_tr_b16 v[78:79], v6 offset:4352
  buffer_load_dwordx4 v2, s[28:31], s4 offen lds
  v_mfma_f32_16x16x32_bf16 v[112:115], v[36:39], v[32:35], 0
  ds_read_b128 v[64:67], v4 offset:2560
  s_add_u32 m0, s27, 98304
  v_mfma_f32_16x16x32_bf16 v[116:119], v[40:43], v[20:23], 0
  ds_read_b64_tr_b16 v[80:81], v7 offset:4096
  s_add_u32 s4, s58, s60
  v_mfma_f32_16x16x32_bf16 v[120:123], v[40:43], v[24:27], 0
  ds_read_b64_tr_b16 v[82:83], v7 offset:4352
  buffer_load_dwordx4 v3, s[32:35], s4 offen lds
  v_mfma_f32_16x16x32_bf16 v[124:127], v[40:43], v[28:31], 0
  ds_read_b128 v[68:71], v5 offset:512
  s_add_u32 m0, s27, 106496
  v_mfma_f32_16x16x32_bf16 v[128:131], v[40:43], v[32:35], 0
  ds_read_b128 v[72:75], v5 offset:2560
  v_mfma_f32_16x16x32_bf16 v[132:135], v[44:47], v[20:23], 0
  ds_read_b64_tr_b16 v[84:85], v6 offset:12288
  s_add_u32 s4, s58, s61
  v_mfma_f32_16x16x32_bf16 v[136:139], v[44:47], v[24:27], 0
  ds_read_b64_tr_b16 v[86:87], v6 offset:12544
  buffer_load_dwordx4 v3, s[32:35], s4 offen lds
  v_mfma_f32_16x16x32_bf16 v[140:143], v[44:47], v[28:31], 0
  ds_read_b64_tr_b16 v[88:89], v7 offset:12288
  s_add_u32 m0, s27, 36864
  v_mfma_f32_16x16x32_bf16 v[144:147], v[44:47], v[32:35], 0
  ds_read_b64_tr_b16 v[90:91], v7 offset:12544
  s_add_u32 s4, s21, 32768
  v_mfma_f32_16x16x32_bf16 v[148:151], v[48:51], v[20:23], 0
  ds_read_b64_tr_b16 v[92:93], v6 offset:20480
  buffer_load_dwordx4 v2, s[28:31], s4 offen lds
  v_mfma_f32_16x16x32_bf16 v[152:155], v[48:51], v[24:27], 0
  ds_read_b64_tr_b16 v[94:95], v6 offset:20736
  s_add_u32 m0, s27, 114688
  v_mfma_f32_16x16x32_bf16 v[156:159], v[48:51], v[28:31], 0
  ds_read_b64_tr_b16 v[96:97], v7 offset:20480
  s_add_u32 s4, s58, s62
  v_mfma_f32_16x16x32_bf16 v[160:163], v[48:51], v[32:35], 0
  ds_read_b64_tr_b16 v[98:99], v7 offset:20736
  v_mfma_f32_16x16x32_bf16 v[164:167], v[52:55], v[20:23], 0
  buffer_load_dwordx4 v3, s[32:35], s4 offen lds
  s_add_u32 m0, s27, 40960
  v_mfma_f32_16x16x32_bf16 v[168:171], v[52:55], v[24:27], 0
  s_add_u32 s4, s21, 65536
  buffer_load_dwordx4 v2, s[28:31], s4 offen lds
  v_mfma_f32_16x16x32_bf16 v[172:175], v[52:55], v[28:31], 0
  s_add_u32 m0, s27, 102400
  s_add_u32 s4, s58, s63
  v_mfma_f32_16x16x32_bf16 v[176:179], v[52:55], v[32:35], 0
  buffer_load_dwordx4 v3, s[32:35], s4 offen lds
  v_mfma_f32_16x16x32_bf16 v[180:183], v[56:59], v[20:23], 0
  s_add_u32 m0, s27, 110592
  s_add_u32 s4, s58, s64
  v_mfma_f32_16x16x32_bf16 v[184:187], v[56:59], v[24:27], 0
  buffer_load_dwordx4 v3, s[32:35], s4 offen lds
  s_add_u32 m0, s27, 45056
  v_mfma_f32_16x16x32_bf16 v[188:191], v[56:59], v[28:31], 0
  s_add_u32 s4, s21, 98304
  buffer_load_dwordx4 v2, s[28:31], s4 offen lds
  v_mfma_f32_16x16x32_bf16 v[192:195], v[56:59], v[32:35], 0
  s_add_u32 m0, s27, 118784
  v_mfma_f32_16x16x32_bf16 v[196:199], v[16:19], v[20:23], 0
  s_add_u32 s4, s58, s65
  buffer_load_dwordx4 v3, s[32:35], s4 offen lds
  v_mfma_f32_16x16x32_bf16 v[204:207], v[20:23], v[20:23], 0
  s_add_u32 s20, s20, 1
  s_and_b32 s20, s20, 7
  v_mfma_f32_16x16x32_bf16 v[200:203], v[16:19], v[24:27], 0
  s_mul_i32 s58, s20, s59
  s_lshl_b32 s21, s20, 7
  v_mfma_f32_16x16x32_bf16 v[208:211], v[24:27], v[24:27], 0
  s_add_u32 s21, s21, s57
  s_cmp_lg_u32 s25, 0
  s_cbranch_scc1 L_cs_23
  v_mfma_f32_16x16x32_bf16 v[212:215], v[16:19], v[36:39], 0
  v_mfma_f32_16x16x32_bf16 v[216:219], v[16:19], v[40:43], 0
  v_mfma_f32_16x16x32_bf16 v[220:223], v[16:19], v[44:47], 0
  v_mfma_f32_16x16x32_bf16 v[224:227], v[16:19], v[48:51], 0
  v_mfma_f32_16x16x32_bf16 v[228:231], v[16:19], v[52:55], 0
  v_mfma_f32_16x16x32_bf16 v[232:235], v[16:19], v[56:59], 0
L_cs_23:
  s_waitcnt vmcnt(12) lgkmcnt(0)
  s_barrier
  v_mfma_f32_16x16x32_bf16 v[100:103], v[76:79], v[60:63], v[100:103]
  ds_read_b128 v[20:23], v4 offset:16384
  s_add_u32 m0, s27, 0
  v_mfma_f32_16x16x32_bf16 v[104:107], v[76:79], v[64:67], v[104:107]
  ds_read_b64_tr_b16 v[36:37], v6 offset:24576
  v_mfma_f32_16x16x32_bf16 v[108:111], v[76:79], v[68:71], v[108:111]
  ds_read_b64_tr_b16 v[38:39], v6 offset:24832
  s_add_u32 s4, s21, 0
  v_mfma_f32_16x16x32_bf16 v[112:115], v[76:79], v[72:75], v[112:115]
  ds_read_b128 v[24:27], v4 offset:18432
  v_mfma_f32_16x16x32_bf16 v[116:119], v[80:83], v[60:63], v[116:119]
  ds_read_b64_tr_b16 v[40:41], v7 offset:24576
  v_mfma_f32_16x16x32_bf16 v[120:123], v[80:83], v[64:67], v[120:123]
  ds_read_b64_tr_b16 v[42:43], v7 offset:24832
  buffer_load_dwordx4 v2, s[28:31], s4 offen lds
  v_mfma_f32_16x16x32_bf16 v[124:127], v[80:83], v[68:71], v[124:127]
  ds_read_b128 v[28:31], v5 offset:16384
  v_mfma_f32_16x16x32_bf16 v[128:131], v[80:83], v[72:75], v[128:131]
  ds_read_b128 v[32:35], v5 offset:18432
  v_mfma_f32_16x16x32_bf16 v[132:135], v[84:87], v[60:63], v[132:135]
  ds_read_b64_tr_b16 v[44:45], v6 offset:32768
  s_add_u32 m0, s27, 49152
  v_mfma_f32_16x16x32_bf16 v[136:139], v[84:87], v[64:67], v[136:139]
  ds_read_b64_tr_b16 v[46:47], v6 offset:33024
  v_mfma_f32_16x16x32_bf16 v[140:143], v[84:87], v[68:71], v[140:143]
  ds_read_b64_tr_b16 v[48:49], v7 offset:32768
  s_add_u32 s4, s58, s60
  v_mfma_f32_16x16x32_bf16 v[144:147], v[84:87], v[72:75], v[144:147]
  ds_read_b64_tr_b16 v[50:51], v7 offset:33024
  v_mfma_f32_16x16x32_bf16 v[148:151], v[88:91], v[60:63], v[148:151]
  ds_read_b64_tr_b16 v[52:53], v6 offset:40960
  v_mfma_f32_16x16x32_bf16 v[152:155], v[88:91], v[64:67], v[152:155]
  ds_read_b64_tr_b16 v[54:55], v6 offset:41216
  buffer_load_dwordx4 v3, s[32:35], s4 offen lds
  v_mfma_f32_16x16x32_bf16 v[156:159], v[88:91], v[68:71], v[156:159]
  ds_read_b64_tr_b16 v[56:57], v7 offset:40960
  v_mfma_f32_16x16x32_bf16 v[160:163], v[88:91], v[72:75], v[160:163]
  ds_read_b64_tr_b16 v[58:59], v7 offset:41216
  v_mfma_f32_16x16x32_bf16 v[164:167], v[92:95], v[60:63], v[164:167]
  s_add_u32 m0, s27, 57344
  v_mfma_f32_16x16x32_bf16 v[168:171], v[92:95], v[64:67], v[168:171]
  s_add_u32 s4, s58, s61
  v_mfma_f32_16x16x32_bf16 v[172:175], v[92:95], v[68:71], v[172:175]
  buffer_load_dwordx4 v3, s[32:35], s4 offen lds
  v_mfma_f32_16x16x32_bf16 v[176:179], v[92:95], v[72:75], v[176:179]
  v_mfma_f32_16x16x32_bf16 v[180:183], v[96:99], v[60:63], v[180:183]
  s_add_u32 m0, s27, 4096
  v_mfma_f32_16x16x32_bf16 v[184:187], v[96:99], v[64:67], v[184:187]
  s_add_u32 s4, s21, 32768
  v_mfma_f32_16x16x32_bf16 v[188:191], v[96:99], v[68:71], v[188:191]
  buffer_load_dwordx4 v2, s[28:31], s4 offen lds
  v_mfma_f32_16x16x32_bf16 v[192:195], v[96:99], v[72:75], v[192:195]
  v_mfma_f32_16x16x32_bf16 v[196:199], v[16:19], v[60:63], v[196:199]
  s_add_u32 m0, s27, 65536
  v_mfma_f32_16x16x32_bf16 v[204:207], v[60:63], v[60:63], v[204:207]
  s_add_u32 s4, s58, s62
  v_mfma_f32_16x16x32_bf16 v[200:203], v[16:19], v[64:67], v[200:203]
  buffer_load_dwordx4 v3, s[32:35], s4 offen lds
  v_mfma_f32_16x16x32_bf16 v[208:211], v[64:67], v[64:67], v[208:211]
  s_cmp_lg_u32 s25, 1
  s_cbranch_scc1 L_cs_24
  v_mfma_f32_16x16x32_bf16 v[212:215], v[16:19], v[76:79], 0
  v_mfma_f32_16x16x32_bf16 v[216:219], v[16:19], v[80:83], 0
  v_mfma_f32_16x16x32_bf16 v[220:223], v[16:19], v[84:87], 0
  v_mfma_f32_16x16x32_bf16 v[224:227], v[16:19], v[88:91], 0
  v_mfma_f32_16x16x32_bf16 v[228:231], v[16:19], v[92:95], 0
  v_mfma_f32_16x16x32_bf16 v[232:235], v[16:19], v[96:99], 0
L_cs_24:
  s_waitcnt lgkmcnt(0)
  v_mfma_f32_16x16x32_bf16 v[100:103], v[36:39], v[20:23], v[100:103]
  ds_read_b128 v[60:63], v4 offset:16896
  s_add_u32 m0, s27, 8192
  v_mfma_f32_16x16x32_bf16 v[104:107], v[36:39], v[24:27], v[104:107]
  ds_read_b64_tr_b16 v[76:77], v6 offset:28672
  s_add_u32 s4, s21, 65536
  v_mfma_f32_16x16x32_bf16 v[108:111], v[36:39], v[28:31], v[108:111]
  ds_read_b64_tr_b16 v[78:79], v6 offset:28928
  v_mfma_f32_16x16x32_bf16 v[112:115], v[36:39], v[32:35], v[112:115]
  ds_read_b128 v[64:67], v4 offset:18944
  buffer_load_dwordx4 v2, s[28:31], s4 offen lds
  v_mfma_f32_16x16x32_bf16 v[116:119], v[40:43], v[20:23], v[116:119]
  ds_read_b64_tr_b16 v[80:81], v7 offset:28672
  v_mfma_f32_16x16x32_bf16 v[120:123], v[40:43], v[24:27], v[120:123]
  ds_read_b64_tr_b16 v[82:83], v7 offset:28928
  s_add_u32 m0, s27, 53248
  v_mfma_f32_16x16x32_bf16 v[124:127], v[40:43], v[28:31], v[124:127]
  ds_read_b128 v[68:71], v5 offset:16896
  v_mfma_f32_16x16x32_bf16 v[128:131], v[40:43], v[32:35], v[128:131]
  ds_read_b128 v[72:75], v5 offset:18944
  s_add_u32 s4, s58, s63
  v_mfma_f32_16x16x32_bf16 v[132:135], v[44:47], v[20:23], v[132:135]
  ds_read_b64_tr_b16 v[84:85], v6 offset:36864
  v_mfma_f32_16x16x32_bf16 v[136:139], v[44:47], v[24:27], v[136:139]
  ds_read_b64_tr_b16 v[86:87], v6 offset:37120
  buffer_load_dwordx4 v3, s[32:35], s4 offen lds
  v_mfma_f32_16x16x32_bf16 v[140:143], v[44:47], v[28:31], v[140:143]
  ds_read_b64_tr_b16 v[88:89], v7 offset:36864
  s_add_u32 m0, s27, 61440
  v_mfma_f32_16x16x32_bf16 v[144:147], v[44:47], v[32:35], v[144:147]
  ds_read_b64_tr_b16 v[90:91], v7 offset:37120
  v_mfma_f32_16x16x32_bf16 v[148:151], v[48:51], v[20:23], v[148:151]
  ds_read_b64_tr_b16 v[92:93], v6 offset:45056
  s_add_u32 s4, s58, s64
  v_mfma_f32_16x16x32_bf16 v[152:155], v[48:51], v[24:27], v[152:155]
  ds_read_b64_tr_b16 v[94:95], v6 offset:45312
  v_mfma_f32_16x16x32_bf16 v[156:159], v[48:51], v[28:31], v[156:159]
  ds_read_b64_tr_b16 v[96:97], v7 offset:45056
  buffer_load_dwordx4 v3, s[32:35], s4 offen lds
  v_mfma_f32_16x16x32_bf16 v[160:163], v[48:51], v[32:35], v[160:163]
  ds_read_b64_tr_b16 v[98:99], v7 offset:45312
  v_mfma_f32_16x16x32_bf16 v[164:167], v[52:55], v[20:23], v[164:167]
  s_add_u32 m0, s27, 12288
  v_mfma_f32_16x16x32_bf16 v[168:171], v[52:55], v[24:27], v[168:171]
  s_add_u32 s4, s21, 98304
  v_mfma_f32_16x16x32_bf16 v[172:175], v[52:55], v[28:31], v[172:175]
  buffer_load_dwordx4 v2, s[28:31], s4 offen lds
  s_add_u32 m0, s27, 69632
  v_mfma_f32_16x16x32_bf16 v[176:179], v[52:55], v[32:35], v[176:179]
  s_add_u32 s4, s58, s65
  v_mfma_f32_16x16x32_bf16 v[180:183], v[56:59], v[20:23], v[180:183]
  buffer_load_dwordx4 v3, s[32:35], s4 offen lds
  v_mfma_f32_16x16x32_bf16 v[184:187], v[56:59], v[24:27], v[184:187]
  s_add_u32 s20, s20, 1
  v_mfma_f32_16x16x32_bf16 v[188:191], v[56:59], v[28:31], v[188:191]
  s_and_b32 s20, s20, 7
  v_mfma_f32_16x16x32_bf16 v[192:195], v[56:59], v[32:35], v[192:195]
  s_mul_i32 s58, s20, s59
  v_mfma_f32_16x16x32_bf16 v[196:199], v[16:19], v[20:23], v[196:199]
  s_lshl_b32 s21, s20, 7
  v_mfma_f32_16x16x32_bf16 v[204:207], v[20:23], v[20:23], v[204:207]
  s_add_u32 s21, s21, s57
  v_mfma_f32_16x16x32_bf16 v[200:203], v[16:19], v[24:27], v[200:203]
  buffer_load_dword v255, v14, s[40:43], 0 offen
  v_mfma_f32_16x16x32_bf16 v[208:211], v[24:27], v[24:27], v[208:211]
  buffer_load_dword v255, v15, s[44:47], 0 offen
  s_cmp_lg_u32 s25, 0
  s_cbranch_scc1 L_cs_25
  v_mfma_f32_16x16x32_bf16 v[212:215], v[16:19], v[36:39], v[212:215]
  v_mfma_f32_16x16x32_bf16 v[216:219], v[16:19], v[40:43], v[216:219]
  v_mfma_f32_16x16x32_bf16 v[220:223], v[16:19], v[44:47], v[220:223]
  v_mfma_f32_16x16x32_bf16 v[224:227], v[16:19], v[48:51], v[224:227]
  v_mfma_f32_16x16x32_bf16 v[228:231], v[16:19], v[52:55], v[228:231]
  v_mfma_f32_16x16x32_bf16 v[232:235], v[16:19], v[56:59], v[232:235]
L_cs_25:
  s_waitcnt vmcnt(12) lgkmcnt(0)
  s_barrier
  s_lshl_b32 s72, s23, 2
  s_add_u32 s72, s72, s24
  s_cmp_lg_u32 s72, 63
  s_cbranch_scc1 L_noinit_26
  v_mov_b32 v248, 1
  v_mov_b32 v249, 0
  s_lshr_b32 s72, s22, 1
  s_lshl_b32 s72, s72, 5
  s_and_b32 s73, s22, 1
  s_lshl_b32 s73, s73, 2
  s_add_u32 s72, s72, s73
  buffer_store_dword v248, v249, s[52:55], s72 offen offset:8 sc1
L_noinit_26:
  v_mfma_f32_16x16x32_bf16 v[100:103], v[76:79], v[60:63], v[100:103]
  ds_read_b128 v[20:23], v4 offset:32768
  s_add_u32 m0, s27, 16384
  v_mfma_f32_16x16x32_bf16 v[104:107], v[76:79], v[64:67], v[104:107]
  ds_read_b64_tr_b16 v[36:37], v8 offset:0
  v_mfma_f32_16x16x32_bf16 v[108:111], v[76:79], v[68:71], v[108:111]
  ds_read_b64_tr_b16 v[38:39], v8 offset:256
  s_add_u32 s4, s21, 0
  v_mfma_f32_16x16x32_bf16 v[112:115], v[76:79], v[72:75], v[112:115]
  ds_read_b128 v[24:27], v4 offset:34816
  v_mfma_f32_16x16x32_bf16 v[116:119], v[80:83], v[60:63], v[116:119]
  ds_read_b64_tr_b16 v[40:41], v9 offset:0
  v_mfma_f32_16x16x32_bf16 v[120:123], v[80:83], v[64:67], v[120:123]
  ds_read_b64_tr_b16 v[42:43], v9 offset:256
  buffer_load_dwordx4 v2, s[28:31], s4 offen lds
  v_mfma_f32_16x16x32_bf16 v[124:127], v[80:83], v[68:71], v[124:127]
  ds_read_b128 v[28:31], v5 offset:32768
  v_mfma_f32_16x16x32_bf16 v[128:131], v[80:83], v[72:75], v[128:131]
  ds_read_b128 v[32:35], v5 offset:34816
  v_mfma_f32_16x16x32_bf16 v[132:135], v[84:87], v[60:63], v[132:135]
  ds_read_b64_tr_b16 v[44:45], v8 offset:8192
  s_add_u32 m0, s27, 73728
  v_mfma_f32_16x16x32_bf16 v[136:139], v[84:87], v[64:67], v[136:139]
  ds_read_b64_tr_b16 v[46:47], v8 offset:8448
  v_mfma_f32_16x16x32_bf16 v[140:143], v[84:87], v[68:71], v[140:143]
  ds_read_b64_tr_b16 v[48:49], v9 offset:8192
  s_add_u32 s4, s58, s60
  v_mfma_f32_16x16x32_bf16 v[144:147], v[84:87], v[72:75], v[144:147]
  ds_read_b64_tr_b16 v[50:51], v9 offset:8448
  v_mfma_f32_16x16x32_bf16 v[148:151], v[88:91], v[60:63], v[148:151]
  ds_read_b64_tr_b16 v[52:53], v8 offset:16384
  v_mfma_f32_16x16x32_bf16 v[152:155], v[88:91], v[64:67], v[152:155]
  ds_read_b64_tr_b16 v[54:55], v8 offset:16640
  buffer_load_dwordx4 v3, s[32:35], s4 offen lds
  v_mfma_f32_16x16x32_bf16 v[156:159], v[88:91], v[68:71], v[156:159]
  ds_read_b64_tr_b16 v[56:57], v9 offset:16384
  v_mfma_f32_16x16x32_bf16 v[160:163], v[88:91], v[72:75], v[160:163]
  ds_read_b64_tr_b16 v[58:59], v9 offset:16640
  v_mfma_f32_16x16x32_bf16 v[164:167], v[92:95], v[60:63], v[164:167]
  s_add_u32 m0, s27, 81920
  v_mfma_f32_16x16x32_bf16 v[168:171], v[92:95], v[64:67], v[168:171]
  s_add_u32 s4, s58, s61
  v_mfma_f32_16x16x32_bf16 v[172:175], v[92:95], v[68:71], v[172:175]
  buffer_load_dwordx4 v3, s[32:35], s4 offen lds
  v_mfma_f32_16x16x32_bf16 v[176:179], v[92:95], v[72:75], v[176:179]
  v_mfma_f32_16x16x32_bf16 v[180:183], v[96:99], v[60:63], v[180:183]
  s_add_u32 m0, s27, 20480
  v_mfma_f32_16x16x32_bf16 v[184:187], v[96:99], v[64:67], v[184:187]
  s_add_u32 s4, s21, 32768
  v_mfma_f32_16x16x32_bf16 v[188:191], v[96:99], v[68:71], v[188:191]
  buffer_load_dwordx4 v2, s[28:31], s4 offen lds
  v_mfma_f32_16x16x32_bf16 v[192:195], v[96:99], v[72:75], v[192:195]
  v_mfma_f32_16x16x32_bf16 v[196:199], v[16:19], v[60:63], v[196:199]
  s_add_u32 m0, s27, 90112
  v_mfma_f32_16x16x32_bf16 v[204:207], v[60:63], v[60:63], v[204:207]
  s_add_u32 s4, s58, s62
  v_mfma_f32_16x16x32_bf16 v[200:203], v[16:19], v[64:67], v[200:203]
  buffer_load_dwordx4 v3, s[32:35], s4 offen lds
  v_mfma_f32_16x16x32_bf16 v[208:211], v[64:67], v[64:67], v[208:211]
  s_cmp_lg_u32 s25, 1
  s_cbranch_scc1 L_cs_27
  v_mfma_f32_16x16x32_bf16 v[212:215], v[16:19], v[76:79], v[212:215]
  v_mfma_f32_16x16x32_bf16 v[216:219], v[16:19], v[80:83], v[216:219]
  v_mfma_f32_16x16x32_bf16 v[220:223], v[16:19], v[84:87], v[220:223]
  v_mfma_f32_16x16x32_bf16 v[224:227], v[16:19], v[88:91], v[224:227]
  v_mfma_f32_16x16x32_bf16 v[228:231], v[16:19], v[92:95], v[228:231]
  v_mfma_f32_16x16x32_bf16 v[232:235], v[16:19], v[96:99], v[232:235]
L_cs_27:
  s_waitcnt lgkmcnt(0)
  v_mfma_f32_16x16x32_bf16 v[100:103], v[36:39], v[20:23], v[100:103]
  ds_read_b128 v[60:63], v4 offset:33280
  s_add_u32 m0, s27, 24576
  v_mfma_f32_16x16x32_bf16 v[104:107], v[36:39], v[24:27], v[104:107]
  ds_read_b64_tr_b16 v[76:77], v8 offset:4096
  v_mfma_f32_16x16x32_bf16 v[108:111], v[36:39], v[28:31], v[108:111]
  ds_read_b64_tr_b16 v[78:79], v8 offset:4352
  s_add_u32 s4, s21, 65536
  v_mfma_f32_16x16x32_bf16 v[112:115], v[36:39], v[32:35], v[112:115]
  ds_read_b128 v[64:67], v4 offset:35328
  v_mfma_f32_16x16x32_bf16 v[116:119], v[40:43], v[20:23], v[116:119]
  ds_read_b64_tr_b16 v[80:81], v9 offset:4096
  buffer_load_dwordx4 v2, s[28:31], s4 offen lds
  v_mfma_f32_16x16x32_bf16 v[120:123], v[40:43], v[24:27], v[120:123]
  ds_read_b64_tr_b16 v[82:83], v9 offset:4352
  v_mfma_f32_16x16x32_bf16 v[124:127], v[40:43], v[28:31], v[124:127]
  ds_read_b128 v[68:71], v5 offset:33280
  s_add_u32 m0, s27, 77824
  v_mfma_f32_16x16x32_bf16 v[128:131], v[40:43], v[32:35], v[128:131]
  ds_read_b128 v[72:75], v5 offset:35328
  v_mfma_f32_16x16x32_bf16 v[132:135], v[44:47], v[20:23], v[132:135]
  ds_read_b64_tr_b16 v[84:85], v8 offset:12288
  s_add_u32 s4, s58, s63
  v_mfma_f32_16x16x32_bf16 v[136:139], v[44:47], v[24:27], v[136:139]
  ds_read_b64_tr_b16 v[86:87], v8 offset:12544
  v_mfma_f32_16x16x32_bf16 v[140:143], v[44:47], v[28:31], v[140:143]
  ds_read_b64_tr_b16 v[88:89], v9 offset:12288
  buffer_load_dwordx4 v3, s[32:35], s4 offen lds
  v_mfma_f32_16x16x32_bf16 v[144:147], v[44:47], v[32:35], v[144:147]
  ds_read_b64_tr_b16 v[90:91], v9 offset:12544
  v_mfma_f32_16x16x32_bf16 v[148:151], v[48:51], v[20:23], v[148:151]
  ds_read_b64_tr_b16 v[92:93], v8 offset:20480
  s_add_u32 m0, s27, 86016
  v_mfma_f32_16x16x32_bf16 v[152:155], v[48:51], v[24:27], v[152:155]
  ds_read_b64_tr_b16 v[94:95], v8 offset:20736
  v_mfma_f32_16x16x32_bf16 v[156:159], v[48:51], v[28:31], v[156:159]
  ds_read_b64_tr_b16 v[96:97], v9 offset:20480
  s_add_u32 s4, s58, s64
  v_mfma_f32_16x16x32_bf16 v[160:163], v[48:51], v[32:35], v[160:163]
  ds_read_b64_tr_b16 v[98:99], v9 offset:20736
  v_mfma_f32_16x16x32_bf16 v[164:167], v[52:55], v[20:23], v[164:167]
  buffer_load_dwordx4 v3, s[32:35], s4 offen lds
  v_mfma_f32_16x16x32_bf16 v[168:171], v[52:55], v[24:27], v[168:171]
  s_add_u32 m0, s27, 28672
  v_mfma_f32_16x16x32_bf16 v[172:175], v[52:55], v[28:31], v[172:175]
  s_add_u32 s4, s21, 98304
  v_mfma_f32_16x16x32_bf16 v[176:179], v[52:55], v[32:35], v[176:179]
  buffer_load_dwordx4 v2, s[28:31], s4 offen lds
  v_mfma_f32_16x16x32_bf16 v[180:183], v[56:59], v[20:23], v[180:183]
  s_add_u32 m0, s27, 94208
  v_mfma_f32_16x16x32_bf16 v[184:187], v[56:59], v[24:27], v[184:187]
  s_add_u32 s4, s58, s65
  v_mfma_f32_16x16x32_bf16 v[188:191], v[56:59], v[28:31], v[188:191]
  buffer_load_dwordx4 v3, s[32:35], s4 offen lds
  v_mfma_f32_16x16x32_bf16 v[192:195], v[56:59], v[32:35], v[192:195]
  s_add_u32 s20, s20, 1
  v_mfma_f32_16x16x32_bf16 v[196:199], v[16:19], v[20:23], v[196:199]
  s_and_b32 s20, s20, 7
  v_mfma_f32_16x16x32_bf16 v[204:207], v[20:23], v[20:23], v[204:207]
  s_mul_i32 s58, s20, s59
  v_mfma_f32_16x16x32_bf16 v[200:203], v[16:19], v[24:27], v[200:203]
  s_lshl_b32 s21, s20, 7
  v_mfma_f32_16x16x32_bf16 v[208:211], v[24:27], v[24:27], v[208:211]
  s_add_u32 s21, s21, s57
  s_cmp_lg_u32 s25, 0
  s_cbranch_scc1 L_cs_28
  v_mfma_f32_16x16x32_bf16 v[212:215], v[16:19], v[36:39], v[212:215]
  v_mfma_f32_16x16x32_bf16 v[216:219], v[16:19], v[40:43], v[216:219]
  v_mfma_f32_16x16x32_bf16 v[220:223], v[16:19], v[44:47], v[220:223]
  v_mfma_f32_16x16x32_bf16 v[224:227], v[16:19], v[48:51], v[224:227]
  v_mfma_f32_16x16x32_bf16 v[228:231], v[16:19], v[52:55], v[228:231]
  v_mfma_f32_16x16x32_bf16 v[232:235], v[16:19], v[56:59], v[232:235]
L_cs_28:
  s_waitcnt vmcnt(12) lgkmcnt(0)
  s_barrier
  v_mfma_f32_16x16x32_bf16 v[100:103], v[76:79], v[60:63], v[100:103]
  ds_read_b128 v[20:23], v4 offset:0
  s_add_u32 m0, s27, 32768
  v_mfma_f32_16x16x32_bf16 v[104:107], v[76:79], v[64:67], v[104:107]
  ds_read_b64_tr_b16 v[36:37], v6 offset:0
  v_mfma_f32_16x16x32_bf16 v[108:111], v[76:79], v[68:71], v[108:111]
  ds_read_b64_tr_b16 v[38:39], v6 offset:256
  s_add_u32 s4, s21, 0
  v_mfma_f32_16x16x32_bf16 v[112:115], v[76:79], v[72:75], v[112:115]
  ds_read_b128 v[24:27], v4 offset:2048
  v_mfma_f32_16x16x32_bf16 v[116:119], v[80:83], v[60:63], v[116:119]
  ds_read_b64_tr_b16 v[40:41], v7 offset:0
  v_mfma_f32_16x16x32_bf16 v[120:123], v[80:83], v[64:67], v[120:123]
  ds_read_b64_tr_b16 v[42:43], v7 offset:256
  buffer_load_dwordx4 v2, s[28:31], s4 offen lds
  v_mfma_f32_16x16x32_bf16 v[124:127], v[80:83], v[68:71], v[124:127]
  ds_read_b128 v[28:31], v5 offset:0
  v_mfma_f32_16x16x32_bf16 v[128:131], v[80:83], v[72:75], v[128:131]
  ds_read_b128 v[32:35], v5 offset:2048
  v_mfma_f32_16x16x32_bf16 v[132:135], v[84:87], v[60:63], v[132:135]
  ds_read_b64_tr_b16 v[44:45], v6 offset:8192
  s_add_u32 m0, s27, 98304
  v_mfma_f32_16x16x32_bf16 v[136:139], v[84:87], v[64:67], v[136:139]
  ds_read_b64_tr_b16 v[46:47], v6 offset:8448
  v_mfma_f32_16x16x32_bf16 v[140:143], v[84:87], v[68:71], v[140:143]
  ds_read_b64_tr_b16 v[48:49], v7 offset:8192
  s_add_u32 s4, s58, s60
  v_mfma_f32_16x16x32_bf16 v[144:147], v[84:87], v[72:75], v[144:147]
  ds_read_b64_tr_b16 v[50:51], v7 offset:8448
  v_mfma_f32_16x16x32_bf16 v[148:151], v[88:91], v[60:63], v[148:151]
  ds_read_b64_tr_b16 v[52:53], v6 offset:16384
  v_mfma_f32_16x16x32_bf16 v[152:155], v[88:91], v[64:67], v[152:155]
  ds_read_b64_tr_b16 v[54:55], v6 offset:16640
  buffer_load_dwordx4 v3, s[32:35], s4 offen lds
  v_mfma_f32_16x16x32_bf16 v[156:159], v[88:91], v[68:71], v[156:159]
  ds_read_b64_tr_b16 v[56:57], v7 offset:16384
  v_mfma_f32_16x16x32_bf16 v[160:163], v[88:91], v[72:75], v[160:163]
  ds_read_b64_tr_b16 v[58:59], v7 offset:16640
  v_mfma_f32_16x16x32_bf16 v[164:167], v[92:95], v[60:63], v[164:167]
  s_add_u32 m0, s27, 106496
  v_mfma_f32_16x16x32_bf16 v[168:171], v[92:95], v[64:67], v[168:171]
  s_add_u32 s4, s58, s61
  v_mfma_f32_16x16x32_bf16 v[172:175], v[92:95], v[68:71], v[172:175]
  buffer_load_dwordx4 v3, s[32:35], s4 offen lds
  v_mfma_f32_16x16x32_bf16 v[176:179], v[92:95], v[72:75], v[176:179]
  v_mfma_f32_16x16x32_bf16 v[180:183], v[96:99], v[60:63], v[180:183]
  s_add_u32 m0, s27, 36864
  v_mfma_f32_16x16x32_bf16 v[184:187], v[96:99], v[64:67], v[184:187]
  s_add_u32 s4, s21, 32768
  v_mfma_f32_16x16x32_bf16 v[188:191], v[96:99], v[68:71], v[188:191]
  buffer_load_dwordx4 v2, s[28:31], s4 offen lds
  v_mfma_f32_16x16x32_bf16 v[192:195], v[96:99], v[72:75], v[192:195]
  v_mfma_f32_16x16x32_bf16 v[196:199], v[16:19], v[60:63], v[196:199]
  s_add_u32 m0, s27, 114688
  v_mfma_f32_16x16x32_bf16 v[204:207], v[60:63], v[60:63], v[204:207]
  s_add_u32 s4, s58, s62
  v_mfma_f32_16x16x32_bf16 v[200:203], v[16:19], v[64:67], v[200:203]
  buffer_load_dwordx4 v3, s[32:35], s4 offen lds
  v_mfma_f32_16x16x32_bf16 v[208:211], v[64:67], v[64:67], v[208:211]
  s_cmp_lg_u32 s25, 1
  s_cbranch_scc1 L_cs_29
  v_mfma_f32_16x16x32_bf16 v[212:215], v[16:19], v[76:79], v[212:215]
  v_mfma_f32_16x16x32_bf16 v[216:219], v[16:19], v[80:83], v[216:219]
  v_mfma_f32_16x16x32_bf16 v[220:223], v[16:19], v[84:87], v[220:223]
  v_mfma_f32_16x16x32_bf16 v[224:227], v[16:19], v[88:91], v[224:227]
  v_mfma_f32_16x16x32_bf16 v[228:231], v[16:19], v[92:95], v[228:231]
  v_mfma_f32_16x16x32_bf16 v[232:235], v[16:19], v[96:99], v[232:235]
L_cs_29:
  s_waitcnt lgkmcnt(0)
  v_mfma_f32_16x16x32_bf16 v[100:103], v[36:39], v[20:23], v[100:103]
  ds_read_b128 v[60:63], v4 offset:512
  s_add_u32 m0, s27, 40960
  v_mfma_f32_16x16x32_bf16 v[104:107], v[36:39], v[24:27], v[104:107]
  ds_read_b64_tr_b16 v[76:77], v6 offset:4096
  s_add_u32 s4, s21, 65536
  v_mfma_f32_16x16x32_bf16 v[108:111], v[36:39], v[28:31], v[108:111]
  ds_read_b64_tr_b16 v[78:79], v6 offset:4352
  buffer_load_dwordx4 v2, s[28:31], s4 offen lds
  v_mfma_f32_16x16x32_bf16 v[112:115], v[36:39], v[32:35], v[112:115]
  ds_read_b128 v[64:67], v4 offset:2560
  s_add_u32 m0, s27, 102400
  v_mfma_f32_16x16x32_bf16 v[116:119], v[40:43], v[20:23], v[116:119]
  ds_read_b64_tr_b16 v[80:81], v7 offset:4096
  s_add_u32 s4, s58, s63
  v_mfma_f32_16x16x32_bf16 v[120:123], v[40:43], v[24:27], v[120:123]
  ds_read_b64_tr_b16 v[82:83], v7 offset:4352
  v_mfma_f32_16x16x32_bf16 v[124:127], v[40:43], v[28:31], v[124:127]
  ds_read_b128 v[68:71], v5 offset:512
  buffer_load_dwordx4 v3, s[32:35], s4 offen lds
  v_mfma_f32_16x16x32_bf16 v[128:131], v[40:43], v[32:35], v[128:131]
  ds_read_b128 v[72:75], v5 offset:2560
  s_add_u32 m0, s27, 110592
  v_mfma_f32_16x16x32_bf16 v[132:135], v[44:47], v[20:23], v[132:135]
  ds_read_b64_tr_b16 v[84:85], v6 offset:12288
  s_add_u32 s4, s58, s64
  v_mfma_f32_16x16x32_bf16 v[136:139], v[44:47], v[24:27], v[136:139]
  ds_read_b64_tr_b16 v[86:87], v6 offset:12544
  buffer_load_dwordx4 v3, s[32:35], s4 offen lds
  v_mfma_f32_16x16x32_bf16 v[140:143], v[44:47], v[28:31], v[140:143]
  ds_read_b64_tr_b16 v[88:89], v7 offset:12288
  s_add_u32 m0, s27, 45056
  v_mfma_f32_16x16x32_bf16 v[144:147], v[44:47], v[32:35], v[144:147]
  ds_read_b64_tr_b16 v[90:91], v7 offset:12544
  v_mfma_f32_16x16x32_bf16 v[148:151], v[48:51], v[20:23], v[148:151]
  ds_read_b64_tr_b16 v[92:93], v6 offset:20480
  s_add_u32 s4, s21, 98304
  v_mfma_f32_16x16x32_bf16 v[152:155], v[48:51], v[24:27], v[152:155]
  ds_read_b64_tr_b16 v[94:95], v6 offset:20736
  buffer_load_dwordx4 v2, s[28:31], s4 offen lds
  v_mfma_f32_16x16x32_bf16 v[156:159], v[48:51], v[28:31], v[156:159]
  ds_read_b64_tr_b16 v[96:97], v7 offset:20480
  s_add_u32 m0, s27, 118784
  v_mfma_f32_16x16x32_bf16 v[160:163], v[48:51], v[32:35], v[160:163]
  ds_read_b64_tr_b16 v[98:99], v7 offset:20736
  s_add_u32 s4, s58, s65
  v_mfma_f32_16x16x32_bf16 v[164:167], v[52:55], v[20:23], v[164:167]
  buffer_load_dwordx4 v3, s[32:35], s4 offen lds
  v_mfma_f32_16x16x32_bf16 v[168:171], v[52:55], v[24:27], v[168:171]
  s_add_u32 s20, s20, 1
  s_and_b32 s20, s20, 7
  v_mfma_f32_16x16x32_bf16 v[172:175], v[52:55], v[28:31], v[172:175]
  s_mul_i32 s58, s20, s59
  s_lshl_b32 s21, s20, 7
  v_mfma_f32_16x16x32_bf16 v[176:179], v[52:55], v[32:35], v[176:179]
  s_add_u32 s21, s21, s57
  v_mfma_f32_16x16x32_bf16 v[180:183], v[56:59], v[20:23], v[180:183]
  s_lshl_b32 s3, s5, 5
  s_add_u32 m0, s70, 122880
  v_mfma_f32_16x16x32_bf16 v[184:187], v[56:59], v[24:27], v[184:187]
  s_add_u32 s4, s3, 0
  buffer_load_dwordx4 v10, s[40:43], s4 offen lds
  v_mfma_f32_16x16x32_bf16 v[188:191], v[56:59], v[28:31], v[188:191]
  s_add_u32 m0, s70, 123904
  v_mfma_f32_16x16x32_bf16 v[192:195], v[56:59], v[32:35], v[192:195]
  s_add_u32 s4, s3, 8192
  buffer_load_dwordx4 v10, s[40:43], s4 offen lds
  v_mfma_f32_16x16x32_bf16 v[196:199], v[16:19], v[20:23], v[196:199]
  s_add_u32 m0, s70, 124928
  s_add_u32 s4, s3, 16384
  v_mfma_f32_16x16x32_bf16 v[204:207], v[20:23], v[20:23], v[204:207]
  buffer_load_dwordx4 v10, s[40:43], s4 offen lds
  v_mfma_f32_16x16x32_bf16 v[200:203], v[16:19], v[24:27], v[200:203]
  s_add_u32 m0, s70, 125952
  s_add_u32 s4, s3, 24576
  v_mfma_f32_16x16x32_bf16 v[208:211], v[24:27], v[24:27], v[208:211]
  buffer_load_dwordx4 v10, s[40:43], s4 offen lds
  s_cmp_lg_u32 s25, 0
  s_cbranch_scc1 L_cs_30
  v_mfma_f32_16x16x32_bf16 v[212:215], v[16:19], v[36:39], v[212:215]
  v_mfma_f32_16x16x32_bf16 v[216:219], v[16:19], v[40:43], v[216:219]
  v_mfma_f32_16x16x32_bf16 v[220:223], v[16:19], v[44:47], v[220:223]
  v_mfma_f32_16x16x32_bf16 v[224:227], v[16:19], v[48:51], v[224:227]
  v_mfma_f32_16x16x32_bf16 v[228:231], v[16:19], v[52:55], v[228:231]
  v_mfma_f32_16x16x32_bf16 v[232:235], v[16:19], v[56:59], v[232:235]
L_cs_30:
  s_waitcnt vmcnt(14) lgkmcnt(0)
  s_barrier
  v_mfma_f32_16x16x32_bf16 v[100:103], v[76:79], v[60:63], v[100:103]
  ds_read_b128 v[20:23], v4 offset:16384
  s_add_u32 m0, s27, 0
  v_mfma_f32_16x16x32_bf16 v[104:107], v[76:79], v[64:67], v[104:107]
  ds_read_b64_tr_b16 v[36:37], v6 offset:24576
  v_mfma_f32_16x16x32_bf16 v[108:111], v[76:79], v[68:71], v[108:111]
  ds_read_b64_tr_b16 v[38:39], v6 offset:24832
  s_add_u32 s4, s21, 0
  v_mfma_f32_16x16x32_bf16 v[112:115], v[76:79], v[72:75], v[112:115]
  ds_read_b128 v[24:27], v4 offset:18432
  v_mfma_f32_16x16x32_bf16 v[116:119], v[80:83], v[60:63], v[116:119]
  ds_read_b64_tr_b16 v[40:41], v7 offset:24576
  v_mfma_f32_16x16x32_bf16 v[120:123], v[80:83], v[64:67], v[120:123]
  ds_read_b64_tr_b16 v[42:43], v7 offset:24832
  buffer_load_dwordx4 v2, s[28:31], s4 offen lds
  v_mfma_f32_16x16x32_bf16 v[124:127], v[80:83], v[68:71], v[124:127]
  ds_read_b128 v[28:31], v5 offset:16384
  v_mfma_f32_16x16x32_bf16 v[128:131], v[80:83], v[72:75], v[128:131]
  ds_read_b128 v[32:35], v5 offset:18432
  v_mfma_f32_16x16x32_bf16 v[132:135], v[84:87], v[60:63], v[132:135]
  ds_read_b64_tr_b16 v[44:45], v6 offset:32768
  s_add_u32 m0, s27, 49152
  v_mfma_f32_16x16x32_bf16 v[136:139], v[84:87], v[64:67], v[136:139]
  ds_read_b64_tr_b16 v[46:47], v6 offset:33024
  v_mfma_f32_16x16x32_bf16 v[140:143], v[84:87], v[68:71], v[140:143]
  ds_read_b64_tr_b16 v[48:49], v7 offset:32768
  s_add_u32 s4, s58, s60
  v_mfma_f32_16x16x32_bf16 v[144:147], v[84:87], v[72:75], v[144:147]
  ds_read_b64_tr_b16 v[50:51], v7 offset:33024
  v_mfma_f32_16x16x32_bf16 v[148:151], v[88:91], v[60:63], v[148:151]
  ds_read_b64_tr_b16 v[52:53], v6 offset:40960
  v_mfma_f32_16x16x32_bf16 v[152:155], v[88:91], v[64:67], v[152:155]
  ds_read_b64_tr_b16 v[54:55], v6 offset:41216
  buffer_load_dwordx4 v3, s[32:35], s4 offen lds
  v_mfma_f32_16x16x32_bf16 v[156:159], v[88:91], v[68:71], v[156:159]
  ds_read_b64_tr_b16 v[56:57], v7 offset:40960
  v_mfma_f32_16x16x32_bf16 v[160:163], v[88:91], v[72:75], v[160:163]
  ds_read_b64_tr_b16 v[58:59], v7 offset:41216
  v_mfma_f32_16x16x32_bf16 v[164:167], v[92:95], v[60:63], v[164:167]
  s_add_u32 m0, s27, 57344
  v_mfma_f32_16x16x32_bf16 v[168:171], v[92:95], v[64:67], v[168:171]
  s_add_u32 s4, s58, s61
  v_mfma_f32_16x16x32_bf16 v[172:175], v[92:95], v[68:71], v[172:175]
  buffer_load_dwordx4 v3, s[32:35], s4 offen lds
  v_mfma_f32_16x16x32_bf16 v[176:179], v[92:95], v[72:75], v[176:179]
  v_mfma_f32_16x16x32_bf16 v[180:183], v[96:99], v[60:63], v[180:183]
  s_add_u32 m0, s27, 4096
  v_mfma_f32_16x16x32_bf16 v[184:187], v[96:99], v[64:67], v[184:187]
  s_add_u32 s4, s21, 32768
  v_mfma_f32_16x16x32_bf16 v[188:191], v[96:99], v[68:71], v[188:191]
  buffer_load_dwordx4 v2, s[28:31], s4 offen lds
  v_mfma_f32_16x16x32_bf16 v[192:195], v[96:99], v[72:75], v[192:195]
  v_mfma_f32_16x16x32_bf16 v[196:199], v[16:19], v[60:63], v[196:199]
  s_add_u32 m0, s27, 65536
  v_mfma_f32_16x16x32_bf16 v[204:207], v[60:63], v[60:63], v[204:207]
  s_add_u32 s4, s58, s62
  v_mfma_f32_16x16x32_bf16 v[200:203], v[16:19], v[64:67], v[200:203]
  buffer_load_dwordx4 v3, s[32:35], s4 offen lds
  v_mfma_f32_16x16x32_bf16 v[208:211], v[64:67], v[64:67], v[208:211]
  s_cmp_lg_u32 s25, 1
  s_cbranch_scc1 L_cs_31
  v_mfma_f32_16x16x32_bf16 v[212:215], v[16:19], v[76:79], v[212:215]
  v_mfma_f32_16x16x32_bf16 v[216:219], v[16:19], v[80:83], v[216:219]
  v_mfma_f32_16x16x32_bf16 v[220:223], v[16:19], v[84:87], v[220:223]
  v_mfma_f32_16x16x32_bf16 v[224:227], v[16:19], v[88:91], v[224:227]
  v_mfma_f32_16x16x32_bf16 v[228:231], v[16:19], v[92:95], v[228:231]
  v_mfma_f32_16x16x32_bf16 v[232:235], v[16:19], v[96:99], v[232:235]
L_cs_31:
  s_waitcnt lgkmcnt(0)
  v_mfma_f32_16x16x32_bf16 v[100:103], v[36:39], v[20:23], v[100:103]
  ds_read_b128 v[60:63], v4 offset:16896
  s_add_u32 m0, s27, 8192
  v_mfma_f32_16x16x32_bf16 v[104:107], v[36:39], v[24:27], v[104:107]
  ds_read_b64_tr_b16 v[76:77], v6 offset:28672
  s_add_u32 s4, s21, 65536
  v_mfma_f32_16x16x32_bf16 v[108:111], v[36:39], v[28:31], v[108:111]
  ds_read_b64_tr_b16 v[78:79], v6 offset:28928
  buffer_load_dwordx4 v2, s[28:31], s4 offen lds
  v_mfma_f32_16x16x32_bf16 v[112:115], v[36:39], v[32:35], v[112:115]
  ds_read_b128 v[64:67], v4 offset:18944
  s_add_u32 m0, s27, 53248
  v_mfma_f32_16x16x32_bf16 v[116:119], v[40:43], v[20:23], v[116:119]
  ds_read_b64_tr_b16 v[80:81], v7 offset:28672
  s_add_u32 s4, s58, s63
  v_mfma_f32_16x16x32_bf16 v[120:123], v[40:43], v[24:27], v[120:123]
  ds_read_b64_tr_b16 v[82:83], v7 offset:28928
  v_mfma_f32_16x16x32_bf16 v[124:127], v[40:43], v[28:31], v[124:127]
  ds_read_b128 v[68:71], v5 offset:16896
  buffer_load_dwordx4 v3, s[32:35], s4 offen lds
  v_mfma_f32_16x16x32_bf16 v[128:131], v[40:43], v[32:35], v[128:131]
  ds_read_b128 v[72:75], v5 offset:18944
  s_add_u32 m0, s27, 61440
  v_mfma_f32_16x16x32_bf16 v[132:135], v[44:47], v[20:23], v[132:135]
  ds_read_b64_tr_b16 v[84:85], v6 offset:36864
  s_add_u32 s4, s58, s64
  v_mfma_f32_16x16x32_bf16 v[136:139], v[44:47], v[24:27], v[136:139]
  ds_read_b64_tr_b16 v[86:87], v6 offset:37120
  buffer_load_dwordx4 v3, s[32:35], s4 offen lds
  v_mfma_f32_16x16x32_bf16 v[140:143], v[44:47], v[28:31], v[140:143]
  ds_read_b64_tr_b16 v[88:89], v7 offset:36864
  s_add_u32 m0, s27, 12288
  v_mfma_f32_16x16x32_bf16 v[144:147], v[44:47], v[32:35], v[144:147]
  ds_read_b64_tr_b16 v[90:91], v7 offset:37120
  v_mfma_f32_16x16x32_bf16 v[148:151], v[48:51], v[20:23], v[148:151]
  ds_read_b64_tr_b16 v[92:93], v6 offset:45056
  s_add_u32 s4, s21, 98304
  v_mfma_f32_16x16x32_bf16 v[152:155], v[48:51], v[24:27], v[152:155]
  ds_read_b64_tr_b16 v[94:95], v6 offset:45312
  buffer_load_dwordx4 v2, s[28:31], s4 offen lds
  v_mfma_f32_16x16x32_bf16 v[156:159], v[48:51], v[28:31], v[156:159]
  ds_read_b64_tr_b16 v[96:97], v7 offset:45056
  s_add_u32 m0, s27, 69632
  v_mfma_f32_16x16x32_bf16 v[160:163], v[48:51], v[32:35], v[160:163]
  ds_read_b64_tr_b16 v[98:99], v7 offset:45312
  s_add_u32 s4, s58, s65
  v_mfma_f32_16x16x32_bf16 v[164:167], v[52:55], v[20:23], v[164:167]
  buffer_load_dwordx4 v3, s[32:35], s4 offen lds
  v_mfma_f32_16x16x32_bf16 v[168:171], v[52:55], v[24:27], v[168:171]
  s_add_u32 s20, s20, 1
  s_and_b32 s20, s20, 7
  v_mfma_f32_16x16x32_bf16 v[172:175], v[52:55], v[28:31], v[172:175]
  s_mul_i32 s58, s20, s59
  s_lshl_b32 s21, s20, 7
  v_mfma_f32_16x16x32_bf16 v[176:179], v[52:55], v[32:35], v[176:179]
  s_add_u32 s21, s21, s57
  v_mfma_f32_16x16x32_bf16 v[180:183], v[56:59], v[20:23], v[180:183]
  s_lshl_b32 s3, s16, 5
  s_add_u32 m0, s70, 139264
  v_mfma_f32_16x16x32_bf16 v[184:187], v[56:59], v[24:27], v[184:187]
  s_add_u32 s4, s3, 0
  buffer_load_dwordx4 v10, s[44:47], s4 offen lds
  v_mfma_f32_16x16x32_bf16 v[188:191], v[56:59], v[28:31], v[188:191]
  s_add_u32 m0, s70, 140288
  v_mfma_f32_16x16x32_bf16 v[192:195], v[56:59], v[32:35], v[192:195]
  s_add_u32 s4, s3, 8192
  buffer_load_dwordx4 v10, s[44:47], s4 offen lds
  v_mfma_f32_16x16x32_bf16 v[196:199], v[16:19], v[20:23], v[196:199]
  s_add_u32 m0, s70, 141312
  s_add_u32 s4, s3, 16384
  v_mfma_f32_16x16x32_bf16 v[204:207], v[20:23], v[20:23], v[204:207]
  buffer_load_dwordx4 v10, s[44:47], s4 offen lds
  v_mfma_f32_16x16x32_bf16 v[200:203], v[16:19], v[24:27], v[200:203]
  s_add_u32 m0, s70, 142336
  s_add_u32 s4, s3, 24576
  v_mfma_f32_16x16x32_bf16 v[208:211], v[24:27], v[24:27], v[208:211]
  buffer_load_dwordx4 v10, s[44:47], s4 offen lds
  s_cmp_lg_u32 s25, 0
  s_cbranch_scc1 L_cs_32
  v_mfma_f32_16x16x32_bf16 v[212:215], v[16:19], v[36:39], v[212:215]
  v_mfma_f32_16x16x32_bf16 v[216:219], v[16:19], v[40:43], v[216:219]
  v_mfma_f32_16x16x32_bf16 v[220:223], v[16:19], v[44:47], v[220:223]
  v_mfma_f32_16x16x32_bf16 v[224:227], v[16:19], v[48:51], v[224:227]
  v_mfma_f32_16x16x32_bf16 v[228:231], v[16:19], v[52:55], v[228:231]
  v_mfma_f32_16x16x32_bf16 v[232:235], v[16:19], v[56:59], v[232:235]
L_cs_32:
  s_waitcnt vmcnt(18) lgkmcnt(0)
  s_barrier
  v_mfma_f32_16x16x32_bf16 v[100:103], v[76:79], v[60:63], v[100:103]
  ds_read_b128 v[20:23], v4 offset:32768
  s_add_u32 m0, s27, 16384
  v_mfma_f32_16x16x32_bf16 v[104:107], v[76:79], v[64:67], v[104:107]
  ds_read_b64_tr_b16 v[36:37], v8 offset:0
  v_mfma_f32_16x16x32_bf16 v[108:111], v[76:79], v[68:71], v[108:111]
  ds_read_b64_tr_b16 v[38:39], v8 offset:256
  s_add_u32 s4, s21, 0
  v_mfma_f32_16x16x32_bf16 v[112:115], v[76:79], v[72:75], v[112:115]
  ds_read_b128 v[24:27], v4 offset:34816
  v_mfma_f32_16x16x32_bf16 v[116:119], v[80:83], v[60:63], v[116:119]
  ds_read_b64_tr_b16 v[40:41], v9 offset:0
  v_mfma_f32_16x16x32_bf16 v[120:123], v[80:83], v[64:67], v[120:123]
  ds_read_b64_tr_b16 v[42:43], v9 offset:256
  buffer_load_dwordx4 v2, s[28:31], s4 offen lds
  v_mfma_f32_16x16x32_bf16 v[124:127], v[80:83], v[68:71], v[124:127]
  ds_read_b128 v[28:31], v5 offset:32768
  v_mfma_f32_16x16x32_bf16 v[128:131], v[80:83], v[72:75], v[128:131]
  ds_read_b128 v[32:35], v5 offset:34816
  v_mfma_f32_16x16x32_bf16 v[132:135], v[84:87], v[60:63], v[132:135]
  ds_read_b64_tr_b16 v[44:45], v8 offset:8192
  s_add_u32 m0, s27, 73728
  v_mfma_f32_16x16x32_bf16 v[136:139], v[84:87], v[64:67], v[136:139]
  ds_read_b64_tr_b16 v[46:47], v8 offset:8448
  v_mfma_f32_16x16x32_bf16 v[140:143], v[84:87], v[68:71], v[140:143]
  ds_read_b64_tr_b16 v[48:49], v9 offset:8192
  s_add_u32 s4, s58, s60
  v_mfma_f32_16x16x32_bf16 v[144:147], v[84:87], v[72:75], v[144:147]
  ds_read_b64_tr_b16 v[50:51], v9 offset:8448
  v_mfma_f32_16x16x32_bf16 v[148:151], v[88:91], v[60:63], v[148:151]
  ds_read_b64_tr_b16 v[52:53], v8 offset:16384
  v_mfma_f32_16x16x32_bf16 v[152:155], v[88:91], v[64:67], v[152:155]
  ds_read_b64_tr_b16 v[54:55], v8 offset:16640
  buffer_load_dwordx4 v3, s[32:35], s4 offen lds
  v_mfma_f32_16x16x32_bf16 v[156:159], v[88:91], v[68:71], v[156:159]
  ds_read_b64_tr_b16 v[56:57], v9 offset:16384
  v_mfma_f32_16x16x32_bf16 v[160:163], v[88:91], v[72:75], v[160:163]
  ds_read_b64_tr_b16 v[58:59], v9 offset:16640
  v_mfma_f32_16x16x32_bf16 v[164:167], v[92:95], v[60:63], v[164:167]
  s_add_u32 m0, s27, 81920
  v_mfma_f32_16x16x32_bf16 v[168:171], v[92:95], v[64:67], v[168:171]
  s_add_u32 s4, s58, s61
  v_mfma_f32_16x16x32_bf16 v[172:175], v[92:95], v[68:71], v[172:175]
  buffer_load_dwordx4 v3, s[32:35], s4 offen lds
  v_mfma_f32_16x16x32_bf16 v[176:179], v[92:95], v[72:75], v[176:179]
  v_mfma_f32_16x16x32_bf16 v[180:183], v[96:99], v[60:63], v[180:183]
  s_add_u32 m0, s27, 20480
  v_mfma_f32_16x16x32_bf16 v[184:187], v[96:99], v[64:67], v[184:187]
  s_add_u32 s4, s21, 32768
  v_mfma_f32_16x16x32_bf16 v[188:191], v[96:99], v[68:71], v[188:191]
  buffer_load_dwordx4 v2, s[28:31], s4 offen lds
  v_mfma_f32_16x16x32_bf16 v[192:195], v[96:99], v[72:75], v[192:195]
  v_mfma_f32_16x16x32_bf16 v[196:199], v[16:19], v[60:63], v[196:199]
  s_add_u32 m0, s27, 90112
  v_mfma_f32_16x16x32_bf16 v[204:207], v[60:63], v[60:63], v[204:207]
  s_add_u32 s4, s58, s62
  v_mfma_f32_16x16x32_bf16 v[200:203], v[16:19], v[64:67], v[200:203]
  buffer_load_dwordx4 v3, s[32:35], s4 offen lds
  v_mfma_f32_16x16x32_bf16 v[208:211], v[64:67], v[64:67], v[208:211]
  s_cmp_lg_u32 s25, 1
  s_cbranch_scc1 L_cs_33
  v_mfma_f32_16x16x32_bf16 v[212:215], v[16:19], v[76:79], v[212:215]
  v_mfma_f32_16x16x32_bf16 v[216:219], v[16:19], v[80:83], v[216:219]
  v_mfma_f32_16x16x32_bf16 v[220:223], v[16:19], v[84:87], v[220:223]
  v_mfma_f32_16x16x32_bf16 v[224:227], v[16:19], v[88:91], v[224:227]
  v_mfma_f32_16x16x32_bf16 v[228:231], v[16:19], v[92:95], v[228:231]
  v_mfma_f32_16x16x32_bf16 v[232:235], v[16:19], v[96:99], v[232:235]
L_cs_33:
  s_waitcnt lgkmcnt(0)
  v_mfma_f32_16x16x32_bf16 v[100:103], v[36:39], v[20:23], v[100:103]
  ds_read_b128 v[60:63], v4 offset:33280
  s_add_u32 m0, s27, 24576
  v_mfma_f32_16x16x32_bf16 v[104:107], v[36:39], v[24:27], v[104:107]
  ds_read_b64_tr_b16 v[76:77], v8 offset:4096
  s_add_u32 s4, s21, 65536
  v_mfma_f32_16x16x32_bf16 v[108:111], v[36:39], v[28:31], v[108:111]
  ds_read_b64_tr_b16 v[78:79], v8 offset:4352
  v_mfma_f32_16x16x32_bf16 v[112:115], v[36:39], v[32:35], v[112:115]
  ds_read_b128 v[64:67], v4 offset:35328
  buffer_load_dwordx4 v2, s[28:31], s4 offen lds
  v_mfma_f32_16x16x32_bf16 v[116:119], v[40:43], v[20:23], v[116:119]
  ds_read_b64_tr_b16 v[80:81], v9 offset:4096
  v_mfma_f32_16x16x32_bf16 v[120:123], v[40:43], v[24:27], v[120:123]
  ds_read_b64_tr_b16 v[82:83], v9 offset:4352
  s_add_u32 m0, s27, 77824
  v_mfma_f32_16x16x32_bf16 v[124:127], v[40:43], v[28:31], v[124:127]
  ds_read_b128 v[68:71], v5 offset:33280
  s_add_u32 s4, s58, s63
  v_mfma_f32_16x16x32_bf16 v[128:131], v[40:43], v[32:35], v[128:131]
  ds_read_b128 v[72:75], v5 offset:35328
  v_mfma_f32_16x16x32_bf16 v[132:135], v[44:47], v[20:23], v[132:135]
  ds_read_b64_tr_b16 v[84:85], v8 offset:12288
  buffer_load_dwordx4 v3, s[32:35], s4 offen lds
  v_mfma_f32_16x16x32_bf16 v[136:139], v[44:47], v[24:27], v[136:139]
  ds_read_b64_tr_b16 v[86:87], v8 offset:12544
  v_mfma_f32_16x16x32_bf16 v[140:143], v[44:47], v[28:31], v[140:143]
  ds_read_b64_tr_b16 v[88:89], v9 offset:12288
  s_add_u32 m0, s27, 86016
  v_mfma_f32_16x16x32_bf16 v[144:147], v[44:47], v[32:35], v[144:147]
  ds_read_b64_tr_b16 v[90:91], v9 offset:12544
  s_add_u32 s4, s58, s64
  v_mfma_f32_16x16x32_bf16 v[148:151], v[48:51], v[20:23], v[148:151]
  ds_read_b64_tr_b16 v[92:93], v8 offset:20480
  v_mfma_f32_16x16x32_bf16 v[152:155], v[48:51], v[24:27], v[152:155]
  ds_read_b64_tr_b16 v[94:95], v8 offset:20736
  buffer_load_dwordx4 v3, s[32:35], s4 offen lds
  v_mfma_f32_16x16x32_bf16 v[156:159], v[48:51], v[28:31], v[156:159]
  ds_read_b64_tr_b16 v[96:97], v9 offset:20480
  v_mfma_f32_16x16x32_bf16 v[160:163], v[48:51], v[32:35], v[160:163]
  ds_read_b64_tr_b16 v[98:99], v9 offset:20736
  s_add_u32 m0, s27, 28672
  v_mfma_f32_16x16x32_bf16 v[164:167], v[52:55], v[20:23], v[164:167]
  s_add_u32 s4, s21, 98304
  v_mfma_f32_16x16x32_bf16 v[168:171], v[52:55], v[24:27], v[168:171]
  buffer_load_dwordx4 v2, s[28:31], s4 offen lds
  v_mfma_f32_16x16x32_bf16 v[172:175], v[52:55], v[28:31], v[172:175]
  s_add_u32 m0, s27, 94208
  s_add_u32 s4, s58, s65
  v_mfma_f32_16x16x32_bf16 v[176:179], v[52:55], v[32:35], v[176:179]
  buffer_load_dwordx4 v3, s[32:35], s4 offen lds
  v_mfma_f32_16x16x32_bf16 v[180:183], v[56:59], v[20:23], v[180:183]
  s_getpc_b64 s[82:83]
L_cp_34:
  v_mfma_f32_16x16x32_bf16 v[184:187], v[56:59], v[24:27], v[184:187]
  s_bfe_u32 s72, s2, 0x20003
  v_mfma_f32_16x16x32_bf16 v[188:191], v[56:59], v[28:31], v[188:191]
  s_lshl_b32 s73, s24, 6
  v_mfma_f32_16x16x32_bf16 v[192:195], v[56:59], v[32:35], v[192:195]
  s_add_u32 s72, s72, s73
  v_and_b32 v13, 15, v1
  v_mfma_f32_16x16x32_bf16 v[196:199], v[16:19], v[20:23], v[196:199]
  v_lshl_add_u32 v13, v13, 2, s72
  v_mfma_f32_16x16x32_bf16 v[204:207], v[20:23], v[20:23], v[204:207]
  v_lshlrev_b32 v13, 7, v13
  v_mfma_f32_16x16x32_bf16 v[200:203], v[16:19], v[24:27], v[200:203]
  v_min_u32 v13, L_code_end - L_cp_34 - 4, v13
  v_mfma_f32_16x16x32_bf16 v[208:211], v[24:27], v[24:27], v[208:211]
  global_load_dword v255, v13, s[82:83]
  s_cmp_lg_u32 s25, 0
  s_cbranch_scc1 L_cs_35
  v_mfma_f32_16x16x32_bf16 v[212:215], v[16:19], v[36:39], v[212:215]
  v_mfma_f32_16x16x32_bf16 v[216:219], v[16:19], v[40:43], v[216:219]
  v_mfma_f32_16x16x32_bf16 v[220:223], v[16:19], v[44:47], v[220:223]
  v_mfma_f32_16x16x32_bf16 v[224:227], v[16:19], v[48:51], v[224:227]
  v_mfma_f32_16x16x32_bf16 v[228:231], v[16:19], v[52:55], v[228:231]
  v_mfma_f32_16x16x32_bf16 v[232:235], v[16:19], v[56:59], v[232:235]
L_cs_35:
  s_waitcnt vmcnt(15) lgkmcnt(0)
  s_barrier
  v_mfma_f32_16x16x32_bf16 v[100:103], v[76:79], v[60:63], v[100:103]
  ds_read_b128 v[20:23], v4 offset:0
  s_waitcnt vmcnt(25)
  v_mfma_f32_16x16x32_bf16 v[104:107], v[76:79], v[64:67], v[104:107]
  ds_read_b64_tr_b16 v[36:37], v6 offset:0
  v_add_u32 v248, 122880, v11
  v_mfma_f32_16x16x32_bf16 v[108:111], v[76:79], v[68:71], v[108:111]
  ds_read_b64_tr_b16 v[38:39], v6 offset:256
  v_mfma_f32_16x16x32_bf16 v[112:115], v[76:79], v[72:75], v[112:115]
  ds_read_b128 v[24:27], v4 offset:2048
  v_add_u32 v249, 122880, v12
  v_mfma_f32_16x16x32_bf16 v[116:119], v[80:83], v[60:63], v[116:119]
  ds_read_b64_tr_b16 v[40:41], v7 offset:0
  v_mfma_f32_16x16x32_bf16 v[120:123], v[80:83], v[64:67], v[120:123]
  ds_read_b64_tr_b16 v[42:43], v7 offset:256
  ds_read_b64_tr_b16 a[0:1], v248 offset:0
  v_mfma_f32_16x16x32_bf16 v[124:127], v[80:83], v[68:71], v[124:127]
  ds_read_b128 v[28:31], v5 offset:0
  ds_read_b64_tr_b16 a[2:3], v248 offset:2048
  v_mfma_f32_16x16x32_bf16 v[128:131], v[80:83], v[72:75], v[128:131]
  ds_read_b128 v[32:35], v5 offset:2048
  v_mfma_f32_16x16x32_bf16 v[132:135], v[84:87], v[60:63], v[132:135]
  ds_read_b64_tr_b16 v[44:45], v6 offset:8192
  ds_read_b64_tr_b16 a[4:5], v249 offset:0
  v_mfma_f32_16x16x32_bf16 v[136:139], v[84:87], v[64:67], v[136:139]
  ds_read_b64_tr_b16 v[46:47], v6 offset:8448
  v_mfma_f32_16x16x32_bf16 v[140:143], v[84:87], v[68:71], v[140:143]
  ds_read_b64_tr_b16 v[48:49], v7 offset:8192
  ds_read_b64_tr_b16 a[6:7], v249 offset:2048
  v_mfma_f32_16x16x32_bf16 v[144:147], v[84:87], v[72:75], v[144:147]
  ds_read_b64_tr_b16 v[50:51], v7 offset:8448
  ds_read_b64_tr_b16 a[8:9], v248 offset:512
  v_mfma_f32_16x16x32_bf16 v[148:151], v[88:91], v[60:63], v[148:151]
  ds_read_b64_tr_b16 v[52:53], v6 offset:16384
  v_mfma_f32_16x16x32_bf16 v[152:155], v[88:91], v[64:67], v[152:155]
  ds_read_b64_tr_b16 v[54:55], v6 offset:16640
  ds_read_b64_tr_b16 a[10:11], v248 offset:2560
  v_mfma_f32_16x16x32_bf16 v[156:159], v[88:91], v[68:71], v[156:159]
  ds_read_b64_tr_b16 v[56:57], v7 offset:16384
  v_mfma_f32_16x16x32_bf16 v[160:163], v[88:91], v[72:75], v[160:163]
  ds_read_b64_tr_b16 v[58:59], v7 offset:16640
  ds_read_b64_tr_b16 a[12:13], v249 offset:512
  v_mfma_f32_16x16x32_bf16 v[164:167], v[92:95], v[60:63], v[164:167]
  ds_read_b64_tr_b16 a[14:15], v249 offset:2560
  v_mfma_f32_16x16x32_bf16 v[168:171], v[92:95], v[64:67], v[168:171]
  s_lshl_b32 s3, s6, 5
  v_mfma_f32_16x16x32_bf16 v[172:175], v[92:95], v[68:71], v[172:175]
  s_add_u32 m0, s70, 32768
  s_add_u32 s4, s3, 0
  v_mfma_f32_16x16x32_bf16 v[176:179], v[92:95], v[72:75], v[176:179]
  buffer_load_dwordx4 v10, s[40:43], s4 offen lds
  v_mfma_f32_16x16x32_bf16 v[180:183], v[96:99], v[60:63], v[180:183]
  s_add_u32 m0, s70, 33792
  v_mfma_f32_16x16x32_bf16 v[184:187], v[96:99], v[64:67], v[184:187]
  s_add_u32 s4, s3, 8192
  v_mfma_f32_16x16x32_bf16 v[188:191], v[96:99], v[68:71], v[188:191]
  buffer_load_dwordx4 v10, s[40:43], s4 offen lds
  v_mfma_f32_16x16x32_bf16 v[192:195], v[96:99], v[72:75], v[192:195]
  s_add_u32 m0, s70, 34816
  s_add_u32 s4, s3, 16384
  v_mfma_f32_16x16x32_bf16 v[196:199], v[16:19], v[60:63], v[196:199]
  buffer_load_dwordx4 v10, s[40:43], s4 offen lds
  v_mfma_f32_16x16x32_bf16 v[204:207], v[60:63], v[60:63], v[204:207]
  s_add_u32 m0, s70, 35840
  v_mfma_f32_16x16x32_bf16 v[200:203], v[16:19], v[64:67], v[200:203]
  s_add_u32 s4, s3, 24576
  v_mfma_f32_16x16x32_bf16 v[208:211], v[64:67], v[64:67], v[208:211]
  buffer_load_dwordx4 v10, s[40:43], s4 offen lds
  s_cmp_lg_u32 s25, 1
  s_cbranch_scc1 L_cs_36
  v_mfma_f32_16x16x32_bf16 v[212:215], v[16:19], v[76:79], v[212:215]
  v_mfma_f32_16x16x32_bf16 v[216:219], v[16:19], v[80:83], v[216:219]
  v_mfma_f32_16x16x32_bf16 v[220:223], v[16:19], v[84:87], v[220:223]
  v_mfma_f32_16x16x32_bf16 v[224:227], v[16:19], v[88:91], v[224:227]
  v_mfma_f32_16x16x32_bf16 v[228:231], v[16:19], v[92:95], v[228:231]
  v_mfma_f32_16x16x32_bf16 v[232:235], v[16:19], v[96:99], v[232:235]
L_cs_36:
  s_waitcnt lgkmcnt(0)
  v_mfma_f32_16x16x32_bf16 v[100:103], v[36:39], v[20:23], v[100:103]
  ds_read_b128 v[60:63], v4 offset:512
  v_lshrrev_b32 v14, 3, v1
  v_mfma_f32_16x16x32_bf16 v[104:107], v[36:39], v[24:27], v[104:107]
  ds_read_b64_tr_b16 v[76:77], v6 offset:4096
  v_lshlrev_b32 v14, 10, v14
  v_mfma_f32_16x16x32_bf16 v[108:111], v[36:39], v[28:31], v[108:111]
  ds_read_b64_tr_b16 v[78:79], v6 offset:4352
  v_and_b32 v15, 7, v1
  v_mfma_f32_16x16x32_bf16 v[112:115], v[36:39], v[32:35], v[112:115]
  ds_read_b128 v[64:67], v4 offset:2560
  v_lshl_add_u32 v14, v15, 4, v14
  v_mfma_f32_16x16x32_bf16 v[116:119], v[40:43], v[20:23], v[116:119]
  ds_read_b64_tr_b16 v[80:81], v7 offset:4096
  s_lshl_b32 s72, s24, 11
  v_mfma_f32_16x16x32_bf16 v[120:123], v[40:43], v[24:27], v[120:123]
  ds_read_b64_tr_b16 v[82:83], v7 offset:4352
  s_add_u32 m0, s72, 114688
  v_mfma_f32_16x16x32_bf16 v[124:127], v[40:43], v[28:31], v[124:127]
  ds_read_b128 v[68:71], v5 offset:512
  s_nop 0
  v_mfma_f32_16x16x32_bf16 v[128:131], v[40:43], v[32:35], v[128:131]
  ds_read_b128 v[72:75], v5 offset:2560
  v_mfma_f32_16x16x32_bf16 v[132:135], v[44:47], v[20:23], v[132:135]
  ds_read_b64_tr_b16 v[84:85], v6 offset:12288
  buffer_load_dwordx4 v14, s[28:31], s93 offen lds
  v_mfma_f32_16x16x32_bf16 v[136:139], v[44:47], v[24:27], v[136:139]
  ds_read_b64_tr_b16 v[86:87], v6 offset:12544
  s_add_u32 m0, s72, 115712
  v_mfma_f32_16x16x32_bf16 v[140:143], v[44:47], v[28:31], v[140:143]
  ds_read_b64_tr_b16 v[88:89], v7 offset:12288
  s_add_u32 s4, s93, 8192
  v_mfma_f32_16x16x32_bf16 v[144:147], v[44:47], v[32:35], v[144:147]
  ds_read_b64_tr_b16 v[90:91], v7 offset:12544
  buffer_load_dwordx4 v14, s[28:31], s4 offen lds
  v_mfma_f32_16x16x32_bf16 v[148:151], v[48:51], v[20:23], v[148:151]
  ds_read_b64_tr_b16 v[92:93], v6 offset:20480
  s_waitcnt vmcnt(17)
  v_mfma_f32_16x16x32_bf16 v[152:155], v[48:51], v[24:27], v[152:155]
  ds_read_b64_tr_b16 v[94:95], v6 offset:20736
  v_add_u32 v250, 139264, v11
  v_mfma_f32_16x16x32_bf16 v[156:159], v[48:51], v[28:31], v[156:159]
  ds_read_b64_tr_b16 v[96:97], v7 offset:20480
  v_add_u32 v251, 139264, v12
  v_mfma_f32_16x16x32_bf16 v[160:163], v[48:51], v[32:35], v[160:163]
  ds_read_b64_tr_b16 v[98:99], v7 offset:20736
  v_mfma_f32_16x16x32_bf16 v[164:167], v[52:55], v[20:23], v[164:167]
  ds_read_b64_tr_b16 a[176:177], v250 offset:0
  ds_read_b64_tr_b16 a[178:179], v250 offset:2048
  v_mfma_f32_16x16x32_bf16 v[168:171], v[52:55], v[24:27], v[168:171]
  ds_read_b64_tr_b16 a[180:181], v251 offset:0
  ds_read_b64_tr_b16 a[182:183], v251 offset:2048
  v_mfma_f32_16x16x32_bf16 v[172:175], v[52:55], v[28:31], v[172:175]
  ds_read_b64_tr_b16 a[184:185], v250 offset:512
  ds_read_b64_tr_b16 a[186:187], v250 offset:2560
  v_mfma_f32_16x16x32_bf16 v[176:179], v[52:55], v[32:35], v[176:179]
  ds_read_b64_tr_b16 a[188:189], v251 offset:512
  v_mfma_f32_16x16x32_bf16 v[180:183], v[56:59], v[20:23], v[180:183]
  ds_read_b64_tr_b16 a[190:191], v251 offset:2560
  s_lshl_b32 s3, s7, 5
  v_mfma_f32_16x16x32_bf16 v[184:187], v[56:59], v[24:27], v[184:187]
  s_add_u32 m0, s70, 98304
  s_add_u32 s4, s3, 0
  v_mfma_f32_16x16x32_bf16 v[188:191], v[56:59], v[28:31], v[188:191]
  buffer_load_dwordx4 v10, s[40:43], s4 offen lds
  s_add_u32 m0, s70, 99328
  v_mfma_f32_16x16x32_bf16 v[192:195], v[56:59], v[32:35], v[192:195]
  s_add_u32 s4, s3, 8192
  v_mfma_f32_16x16x32_bf16 v[196:199], v[16:19], v[20:23], v[196:199]
  buffer_load_dwordx4 v10, s[40:43], s4 offen lds
  s_add_u32 m0, s70, 100352
  v_mfma_f32_16x16x32_bf16 v[204:207], v[20:23], v[20:23], v[204:207]
  s_add_u32 s4, s3, 16384
  buffer_load_dwordx4 v10, s[40:43], s4 offen lds
  v_mfma_f32_16x16x32_bf16 v[200:203], v[16:19], v[24:27], v[200:203]
  s_add_u32 m0, s70, 101376
  s_add_u32 s4, s3, 24576
  v_mfma_f32_16x16x32_bf16 v[208:211], v[24:27], v[24:27], v[208:211]
  buffer_load_dwordx4 v10, s[40:43], s4 offen lds
  s_cmp_lg_u32 s25, 0
  s_cbranch_scc1 L_cs_37
  v_mfma_f32_16x16x32_bf16 v[212:215], v[16:19], v[36:39], v[212:215]
  v_mfma_f32_16x16x32_bf16 v[216:219], v[16:19], v[40:43], v[216:219]
  v_mfma_f32_16x16x32_bf16 v[220:223], v[16:19], v[44:47], v[220:223]
  v_mfma_f32_16x16x32_bf16 v[224:227], v[16:19], v[48:51], v[224:227]
  v_mfma_f32_16x16x32_bf16 v[228:231], v[16:19], v[52:55], v[228:231]
  v_mfma_f32_16x16x32_bf16 v[232:235], v[16:19], v[56:59], v[232:235]
L_cs_37:
  s_waitcnt vmcnt(11) lgkmcnt(0)
  s_barrier
  v_mfma_f32_16x16x32_bf16 v[100:103], v[76:79], v[60:63], v[100:103]
  ds_read_b128 v[20:23], v4 offset:16384
  s_lshl_b32 s3, s8, 5
  v_mfma_f32_16x16x32_bf16 v[104:107], v[76:79], v[64:67], v[104:107]
  ds_read_b64_tr_b16 v[36:37], v6 offset:24576
  s_add_u32 m0, s70, 0
  v_mfma_f32_16x16x32_bf16 v[108:111], v[76:79], v[68:71], v[108:111]
  ds_read_b64_tr_b16 v[38:39], v6 offset:24832
  s_add_u32 s4, s3, 0
  v_mfma_f32_16x16x32_bf16 v[112:115], v[76:79], v[72:75], v[112:115]
  ds_read_b128 v[24:27], v4 offset:18432
  v_mfma_f32_16x16x32_bf16 v[116:119], v[80:83], v[60:63], v[116:119]
  ds_read_b64_tr_b16 v[40:41], v7 offset:24576
  buffer_load_dwordx4 v10, s[40:43], s4 offen lds
  v_mfma_f32_16x16x32_bf16 v[120:123], v[80:83], v[64:67], v[120:123]
  ds_read_b64_tr_b16 v[42:43], v7 offset:24832
  s_add_u32 m0, s70, 1024
  v_mfma_f32_16x16x32_bf16 v[124:127], v[80:83], v[68:71], v[124:127]
  ds_read_b128 v[28:31], v5 offset:16384
  v_mfma_f32_16x16x32_bf16 v[128:131], v[80:83], v[72:75], v[128:131]
  ds_read_b128 v[32:35], v5 offset:18432
  s_add_u32 s4, s3, 8192
  v_mfma_f32_16x16x32_bf16 v[132:135], v[84:87], v[60:63], v[132:135]
  ds_read_b64_tr_b16 v[44:45], v6 offset:32768
  buffer_load_dwordx4 v10, s[40:43], s4 offen lds
  v_mfma_f32_16x16x32_bf16 v[136:139], v[84:87], v[64:67], v[136:139]
  ds_read_b64_tr_b16 v[46:47], v6 offset:33024
  v_mfma_f32_16x16x32_bf16 v[140:143], v[84:87], v[68:71], v[140:143]
  ds_read_b64_tr_b16 v[48:49], v7 offset:32768
  s_add_u32 m0, s70, 2048
  v_mfma_f32_16x16x32_bf16 v[144:147], v[84:87], v[72:75], v[144:147]
  ds_read_b64_tr_b16 v[50:51], v7 offset:33024
  s_add_u32 s4, s3, 16384
  v_mfma_f32_16x16x32_bf16 v[148:151], v[88:91], v[60:63], v[148:151]
  ds_read_b64_tr_b16 v[52:53], v6 offset:40960
  v_mfma_f32_16x16x32_bf16 v[152:155], v[88:91], v[64:67], v[152:155]
  ds_read_b64_tr_b16 v[54:55], v6 offset:41216
  buffer_load_dwordx4 v10, s[40:43], s4 offen lds
  v_mfma_f32_16x16x32_bf16 v[156:159], v[88:91], v[68:71], v[156:159]
  ds_read_b64_tr_b16 v[56:57], v7 offset:40960
  s_add_u32 m0, s70, 3072
  v_mfma_f32_16x16x32_bf16 v[160:163], v[88:91], v[72:75], v[160:163]
  ds_read_b64_tr_b16 v[58:59], v7 offset:41216
  v_mfma_f32_16x16x32_bf16 v[164:167], v[92:95], v[60:63], v[164:167]
  s_add_u32 s4, s3, 24576
  buffer_load_dwordx4 v10, s[40:43], s4 offen lds
  v_mfma_f32_16x16x32_bf16 v[168:171], v[92:95], v[64:67], v[168:171]
  s_lshl_b32 s3, s9, 5
  v_mfma_f32_16x16x32_bf16 v[172:175], v[92:95], v[68:71], v[172:175]
  s_add_u32 m0, s70, 122880
  v_mfma_f32_16x16x32_bf16 v[176:179], v[92:95], v[72:75], v[176:179]
  s_add_u32 s4, s3, 0
  buffer_load_dwordx4 v10, s[40:43], s4 offen lds
  v_mfma_f32_16x16x32_bf16 v[180:183], v[96:99], v[60:63], v[180:183]
  s_add_u32 m0, s70, 123904
  v_mfma_f32_16x16x32_bf16 v[184:187], v[96:99], v[64:67], v[184:187]
  s_add_u32 s4, s3, 8192
  v_mfma_f32_16x16x32_bf16 v[188:191], v[96:99], v[68:71], v[188:191]
  buffer_load_dwordx4 v10, s[40:43], s4 offen lds
  s_add_u32 m0, s70, 124928
  v_mfma_f32_16x16x32_bf16 v[192:195], v[96:99], v[72:75], v[192:195]
  s_add_u32 s4, s3, 16384
  v_mfma_f32_16x16x32_bf16 v[196:199], v[16:19], v[60:63], v[196:199]
  buffer_load_dwordx4 v10, s[40:43], s4 offen lds
  v_mfma_f32_16x16x32_bf16 v[204:207], v[60:63], v[60:63], v[204:207]
  s_add_u32 m0, s70, 125952
  s_add_u32 s4, s3, 24576
  v_mfma_f32_16x16x32_bf16 v[200:203], v[16:19], v[64:67], v[200:203]
  buffer_load_dwordx4 v10, s[40:43], s4 offen lds
  v_mfma_f32_16x16x32_bf16 v[208:211], v[64:67], v[64:67], v[208:211]
  buffer_load_dword v254, v252, s[52:55], 8 offen sc1
  s_cmp_lg_u32 s25, 1
  s_cbranch_scc1 L_cs_38
  v_mfma_f32_16x16x32_bf16 v[212:215], v[16:19], v[76:79], v[212:215]
  v_mfma_f32_16x16x32_bf16 v[216:219], v[16:19], v[80:83], v[216:219]
  v_mfma_f32_16x16x32_bf16 v[220:223], v[16:19], v[84:87], v[220:223]
  v_mfma_f32_16x16x32_bf16 v[224:227], v[16:19], v[88:91], v[224:227]
  v_mfma_f32_16x16x32_bf16 v[228:231], v[16:19], v[92:95], v[228:231]
  v_mfma_f32_16x16x32_bf16 v[232:235], v[16:19], v[96:99], v[232:235]
L_cs_38:
  s_waitcnt lgkmcnt(0)
  v_mfma_f32_16x16x32_bf16 v[196:199], v[16:19], v[20:23], v[196:199]
  ds_read_b128 v[60:63], v4 offset:16896
  ds_read_b64_tr_b16 v[76:77], v6 offset:28672
  v_mfma_f32_16x16x32_bf16 v[204:207], v[20:23], v[20:23], v[204:207]
  ds_read_b64_tr_b16 v[78:79], v6 offset:28928
  ds_read_b128 v[64:67], v4 offset:18944
  v_mfma_f32_16x16x32_bf16 v[200:203], v[16:19], v[24:27], v[200:203]
  ds_read_b64_tr_b16 v[80:81], v7 offset:28672
  ds_read_b64_tr_b16 v[82:83], v7 offset:28928
  v_mfma_f32_16x16x32_bf16 v[208:211], v[24:27], v[24:27], v[208:211]
  ds_read_b128 v[68:71], v5 offset:16896
  ds_read_b128 v[72:75], v5 offset:18944
  v_mfma_f32_16x16x32_bf16 v[100:103], v[36:39], v[20:23], v[100:103]
  ds_read_b64_tr_b16 v[84:85], v6 offset:36864
  ds_read_b64_tr_b16 v[86:87], v6 offset:37120
  v_mfma_f32_16x16x32_bf16 v[104:107], v[36:39], v[24:27], v[104:107]
  ds_read_b64_tr_b16 v[88:89], v7 offset:36864
  ds_read_b64_tr_b16 v[90:91], v7 offset:37120
  v_mfma_f32_16x16x32_bf16 v[108:111], v[36:39], v[28:31], v[108:111]
  ds_read_b64_tr_b16 v[92:93], v6 offset:45056
  ds_read_b64_tr_b16 v[94:95], v6 offset:45312
  v_mfma_f32_16x16x32_bf16 v[112:115], v[36:39], v[32:35], v[112:115]
  ds_read_b64_tr_b16 v[96:97], v7 offset:45056
  ds_read_b64_tr_b16 v[98:99], v7 offset:45312
  v_mfma_f32_16x16x32_bf16 v[116:119], v[40:43], v[20:23], v[116:119]
  v_mfma_f32_16x16x32_bf16 v[120:123], v[40:43], v[24:27], v[120:123]
  v_mfma_f32_16x16x32_bf16 v[124:127], v[40:43], v[28:31], v[124:127]
  v_mfma_f32_16x16x32_bf16 v[128:131], v[40:43], v[32:35], v[128:131]
  s_cmp_lg_u32 s25, 0
  s_cbranch_scc1 L_cs_39
  v_mfma_f32_16x16x32_bf16 v[212:215], v[16:19], v[36:39], v[212:215]
  v_mfma_f32_16x16x32_bf16 v[216:219], v[16:19], v[40:43], v[216:219]
  v_mfma_f32_16x16x32_bf16 v[220:223], v[16:19], v[44:47], v[220:223]
  v_mfma_f32_16x16x32_bf16 v[224:227], v[16:19], v[48:51], v[224:227]
  v_mfma_f32_16x16x32_bf16 v[228:231], v[16:19], v[52:55], v[228:231]
  v_mfma_f32_16x16x32_bf16 v[232:235], v[16:19], v[56:59], v[232:235]
L_cs_39:
  s_waitcnt lgkmcnt(0)
  v_mfma_f32_16x16x32_bf16 v[196:199], v[16:19], v[60:63], v[196:199]
  v_mfma_f32_16x16x32_bf16 v[204:207], v[60:63], v[60:63], v[204:207]
  v_mfma_f32_16x16x32_bf16 v[200:203], v[16:19], v[64:67], v[200:203]
  v_mfma_f32_16x16x32_bf16 v[208:211], v[64:67], v[64:67], v[208:211]
  s_cmp_lg_u32 s25, 1
  s_cbranch_scc1 L_cs_40
  v_mfma_f32_16x16x32_bf16 v[212:215], v[16:19], v[76:79], v[212:215]
  v_mfma_f32_16x16x32_bf16 v[216:219], v[16:19], v[80:83], v[216:219]
  v_mfma_f32_16x16x32_bf16 v[220:223], v[16:19], v[84:87], v[220:223]
  v_mfma_f32_16x16x32_bf16 v[224:227], v[16:19], v[88:91], v[224:227]
  v_mfma_f32_16x16x32_bf16 v[228:231], v[16:19], v[92:95], v[228:231]
  v_mfma_f32_16x16x32_bf16 v[232:235], v[16:19], v[96:99], v[232:235]
L_cs_40:
  v_mfma_f32_16x16x32_bf16 v[132:135], v[44:47], v[20:23], v[132:135]
  s_lshl_b32 s3, s10, 5
  s_add_u32 m0, s70, 49152
  v_mfma_f32_16x16x32_bf16 v[136:139], v[44:47], v[24:27], v[136:139]
  s_add_u32 s4, s3, 0
  buffer_load_dwordx4 v10, s[40:43], s4 offen lds
  v_mfma_f32_16x16x32_bf16 v[140:143], v[44:47], v[28:31], v[140:143]
  s_add_u32 m0, s70, 50176
  s_add_u32 s4, s3, 8192
  v_mfma_f32_16x16x32_bf16 v[144:147], v[44:47], v[32:35], v[144:147]
  buffer_load_dwordx4 v10, s[40:43], s4 offen lds
  s_add_u32 m0, s70, 51200
  v_mfma_f32_16x16x32_bf16 v[148:151], v[48:51], v[20:23], v[148:151]
  s_add_u32 s4, s3, 16384
  buffer_load_dwordx4 v10, s[40:43], s4 offen lds
  v_mfma_f32_16x16x32_bf16 v[152:155], v[48:51], v[24:27], v[152:155]
  ds_write_b32 v237, v212 offset:0
  ds_write_b32 v237, v216 offset:64
  v_mfma_f32_16x16x32_bf16 v[156:159], v[48:51], v[28:31], v[156:159]
  ds_write_b32 v237, v220 offset:128
  ds_write_b32 v237, v224 offset:192
  v_mfma_f32_16x16x32_bf16 v[160:163], v[48:51], v[32:35], v[160:163]
  ds_write_b32 v237, v228 offset:256
  ds_write_b32 v237, v232 offset:320
  v_mfma_f32_16x16x32_bf16 v[164:167], v[52:55], v[20:23], v[164:167]
  v_cndmask_b32 v204, v204, v205, s[94:95]
  v_cndmask_b32 v204, v204, v206, s[96:97]
  v_mfma_f32_16x16x32_bf16 v[168:171], v[52:55], v[24:27], v[168:171]
  v_cndmask_b32 v204, v204, v207, s[98:99]
  v_cndmask_b32 v208, v208, v209, s[94:95]
  v_mfma_f32_16x16x32_bf16 v[172:175], v[52:55], v[28:31], v[172:175]
  v_cndmask_b32 v208, v208, v210, s[96:97]
  v_cndmask_b32 v208, v208, v211, s[98:99]
  v_mfma_f32_16x16x32_bf16 v[176:179], v[52:55], v[32:35], v[176:179]
  v_mul_f32 v196, 0x3b000000, v196
  v_mul_f32 v200, 0x3b000000, v200
  v_mfma_f32_16x16x32_bf16 v[180:183], v[56:59], v[20:23], v[180:183]
  v_mul_f32 v204, 0x3b000000, v204
  v_mul_f32 v208, 0x3b000000, v208
  v_mfma_f32_16x16x32_bf16 v[184:187], v[56:59], v[24:27], v[184:187]
  v_fma_f32 v204, -v196, v196, v204
  v_fma_f32 v208, -v200, v200, v208
  v_mfma_f32_16x16x32_bf16 v[188:191], v[56:59], v[28:31], v[188:191]
  v_max_f32 v204, 0, v204
  v_max_f32 v208, 0, v208
  v_mfma_f32_16x16x32_bf16 v[192:195], v[56:59], v[32:35], v[192:195]
  v_cvt_pk_bf16_f32 v247, v204, v208
  v_lshlrev_b32 v204, 16, v247
  v_mfma_f32_16x16x32_bf16 v[100:103], v[76:79], v[60:63], v[100:103]
  v_and_b32 v208, 0xffff0000, v247
  v_mfma_f32_16x16x32_bf16 v[104:107], v[76:79], v[64:67], v[104:107]
  v_add_f32 v204, 0x3727c5ac, v204
  v_add_f32 v208, 0x3727c5ac, v208
  v_mfma_f32_16x16x32_bf16 v[108:111], v[76:79], v[68:71], v[108:111]
  v_cvt_pk_bf16_f32 v247, v204, v208
  v_lshlrev_b32 v204, 16, v247
  v_mfma_f32_16x16x32_bf16 v[112:115], v[76:79], v[72:75], v[112:115]
  v_and_b32 v208, 0xffff0000, v247
  v_sqrt_f32 v204, v204
  v_mfma_f32_16x16x32_bf16 v[116:119], v[80:83], v[60:63], v[116:119]
  v_sqrt_f32 v208, v208
  v_cvt_pk_bf16_f32 v247, v196, v200
  v_mfma_f32_16x16x32_bf16 v[120:123], v[80:83], v[64:67], v[120:123]
  v_lshlrev_b32 v196, 16, v247
  v_and_b32 v200, 0xffff0000, v247
  v_mfma_f32_16x16x32_bf16 v[124:127], v[80:83], v[68:71], v[124:127]
  v_cvt_pk_bf16_f32 v247, v204, v208
  v_lshlrev_b32 v204, 16, v247
  v_mfma_f32_16x16x32_bf16 v[128:131], v[80:83], v[72:75], v[128:131]
  v_and_b32 v208, 0xffff0000, v247
  v_rcp_f32 v204, v204
  v_mfma_f32_16x16x32_bf16 v[132:135], v[84:87], v[60:63], v[132:135]
  v_rcp_f32 v208, v208
  v_sub_f32 v196, 0, v196
  v_mfma_f32_16x16x32_bf16 v[136:139], v[84:87], v[64:67], v[136:139]
  v_sub_f32 v200, 0, v200
  ds_write_b32 v236, v196
  v_mfma_f32_16x16x32_bf16 v[140:143], v[84:87], v[68:71], v[140:143]
  ds_write_b32 v236, v200 offset:64
  ds_write_b32 v236, v204 offset:512
  v_mfma_f32_16x16x32_bf16 v[144:147], v[84:87], v[72:75], v[144:147]
  ds_write_b32 v236, v208 offset:576
  s_waitcnt lgkmcnt(0)
  s_barrier
  v_mfma_f32_16x16x32_bf16 v[148:151], v[88:91], v[60:63], v[148:151]
  ds_read_b128 v[20:23], v242 offset:0
  ds_read_b128 v[196:199], v242 offset:768
  v_mfma_f32_16x16x32_bf16 v[152:155], v[88:91], v[64:67], v[152:155]
  ds_read_b128 v[24:27], v242 offset:64
  ds_read_b128 v[200:203], v242 offset:832
  v_mfma_f32_16x16x32_bf16 v[156:159], v[88:91], v[68:71], v[156:159]
  ds_read_b32 v44, v240 offset:0
  ds_read_b32 v48, v240 offset:512
  v_mfma_f32_16x16x32_bf16 v[160:163], v[88:91], v[72:75], v[160:163]
  ds_read_b32 v45, v240 offset:64
  ds_read_b32 v49, v240 offset:576
  v_mfma_f32_16x16x32_bf16 v[164:167], v[92:95], v[60:63], v[164:167]
  ds_read_b32 v46, v241 offset:128
  ds_read_b32 v50, v241 offset:640
  v_mfma_f32_16x16x32_bf16 v[168:171], v[92:95], v[64:67], v[168:171]
  ds_read_b32 v47, v241 offset:192
  ds_read_b32 v51, v241 offset:704
  v_mfma_f32_16x16x32_bf16 v[172:175], v[92:95], v[68:71], v[172:175]
  ds_read_b128 v[28:31], v242 offset:128
  ds_read_b128 v[204:207], v242 offset:896
  v_mfma_f32_16x16x32_bf16 v[176:179], v[92:95], v[72:75], v[176:179]
  ds_read_b128 v[32:35], v242 offset:192
  ds_read_b128 v[208:211], v242 offset:960
  v_mfma_f32_16x16x32_bf16 v[180:183], v[96:99], v[60:63], v[180:183]
  ds_read_b128 v[36:39], v242 offset:256
  ds_read_b128 v[212:215], v242 offset:1024
  v_mfma_f32_16x16x32_bf16 v[184:187], v[96:99], v[64:67], v[184:187]
  ds_read_b128 v[40:43], v242 offset:320
  ds_read_b128 v[216:219], v242 offset:1088
  v_mfma_f32_16x16x32_bf16 v[188:191], v[96:99], v[68:71], v[188:191]
  v_mfma_f32_16x16x32_bf16 v[192:195], v[96:99], v[72:75], v[192:195]
  s_waitcnt lgkmcnt(8)
  v_pk_add_f32 v[20:21], v[20:21], v[196:197]
  v_pk_add_f32 v[22:23], v[22:23], v[198:199]
  v_pk_add_f32 v[24:25], v[24:25], v[200:201]
  v_pk_add_f32 v[26:27], v[26:27], v[202:203]
  v_pk_fma_f32 v[100:101], v[20:21], v[44:45], v[100:101] op_sel:[0,0,0] op_sel_hi:[1,0,1]
  v_pk_fma_f32 v[102:103], v[22:23], v[44:45], v[102:103] op_sel:[0,0,0] op_sel_hi:[1,0,1]
  v_pk_fma_f32 v[116:117], v[24:25], v[44:45], v[116:117] op_sel:[0,0,0] op_sel_hi:[1,0,1]
  v_pk_fma_f32 v[118:119], v[26:27], v[44:45], v[118:119] op_sel:[0,0,0] op_sel_hi:[1,0,1]
  v_pk_mul_f32 v[100:101], v[100:101], v[48:49] op_sel:[0,0] op_sel_hi:[1,0]
  v_pk_mul_f32 v[102:103], v[102:103], v[48:49] op_sel:[0,0] op_sel_hi:[1,0]
  v_pk_mul_f32 v[116:117], v[116:117], v[48:49] op_sel:[0,0] op_sel_hi:[1,0]
  v_pk_mul_f32 v[118:119], v[118:119], v[48:49] op_sel:[0,0] op_sel_hi:[1,0]
  v_cvt_pk_bf16_f32 v60, v100, v101
  v_cvt_pk_bf16_f32 v61, v102, v103
  v_cvt_pk_bf16_f32 v62, v116, v117
  v_cvt_pk_bf16_f32 v63, v118, v119
  v_pk_max_i16 v60, v60, 0
  v_pk_max_i16 v61, v61, 0
  v_pk_max_i16 v62, v62, 0
  v_pk_max_i16 v63, v63, 0
  buffer_store_dwordx4 v[60:63], v238, s[36:39], s84 offen sc1
  v_pk_fma_f32 v[104:105], v[20:21], v[44:45], v[104:105] op_sel:[0,1,0] op_sel_hi:[1,1,1]
  v_pk_fma_f32 v[106:107], v[22:23], v[44:45], v[106:107] op_sel:[0,1,0] op_sel_hi:[1,1,1]
  v_pk_fma_f32 v[120:121], v[24:25], v[44:45], v[120:121] op_sel:[0,1,0] op_sel_hi:[1,1,1]
  v_pk_fma_f32 v[122:123], v[26:27], v[44:45], v[122:123] op_sel:[0,1,0] op_sel_hi:[1,1,1]
  v_pk_mul_f32 v[104:105], v[104:105], v[48:49] op_sel:[0,1] op_sel_hi:[1,1]
  v_pk_mul_f32 v[106:107], v[106:107], v[48:49] op_sel:[0,1] op_sel_hi:[1,1]
  v_pk_mul_f32 v[120:121], v[120:121], v[48:49] op_sel:[0,1] op_sel_hi:[1,1]
  v_pk_mul_f32 v[122:123], v[122:123], v[48:49] op_sel:[0,1] op_sel_hi:[1,1]
  v_cvt_pk_bf16_f32 v64, v104, v105
  v_cvt_pk_bf16_f32 v65, v106, v107
  v_cvt_pk_bf16_f32 v66, v120, v121
  v_cvt_pk_bf16_f32 v67, v122, v123
  v_pk_max_i16 v64, v64, 0
  v_pk_max_i16 v65, v65, 0
  v_pk_max_i16 v66, v66, 0
  v_pk_max_i16 v67, v67, 0
  buffer_store_dwordx4 v[64:67], v238, s[36:39], s85 offen sc1
  v_pk_fma_f32 v[108:109], v[20:21], v[46:47], v[108:109] op_sel:[0,0,0] op_sel_hi:[1,0,1]
  v_pk_fma_f32 v[110:111], v[22:23], v[46:47], v[110:111] op_sel:[0,0,0] op_sel_hi:[1,0,1]
  v_pk_fma_f32 v[124:125], v[24:25], v[46:47], v[124:125] op_sel:[0,0,0] op_sel_hi:[1,0,1]
  v_pk_fma_f32 v[126:127], v[26:27], v[46:47], v[126:127] op_sel:[0,0,0] op_sel_hi:[1,0,1]
  v_pk_mul_f32 v[108:109], v[108:109], v[50:51] op_sel:[0,0] op_sel_hi:[1,0]
  v_pk_mul_f32 v[110:111], v[110:111], v[50:51] op_sel:[0,0] op_sel_hi:[1,0]
  v_pk_mul_f32 v[124:125], v[124:125], v[50:51] op_sel:[0,0] op_sel_hi:[1,0]
  v_pk_mul_f32 v[126:127], v[126:127], v[50:51] op_sel:[0,0] op_sel_hi:[1,0]
  v_cvt_pk_bf16_f32 v68, v108, v109
  v_cvt_pk_bf16_f32 v69, v110, v111
  v_cvt_pk_bf16_f32 v70, v124, v125
  v_cvt_pk_bf16_f32 v71, v126, v127
  v_pk_max_i16 v68, v68, 0
  v_pk_max_i16 v69, v69, 0
  v_pk_max_i16 v70, v70, 0
  v_pk_max_i16 v71, v71, 0
  buffer_store_dwordx4 v[68:71], v238, s[36:39], s86 offen sc1
  v_pk_fma_f32 v[112:113], v[20:21], v[46:47], v[112:113] op_sel:[0,1,0] op_sel_hi:[1,1,1]
  v_pk_fma_f32 v[114:115], v[22:23], v[46:47], v[114:115] op_sel:[0,1,0] op_sel_hi:[1,1,1]
  v_pk_fma_f32 v[128:129], v[24:25], v[46:47], v[128:129] op_sel:[0,1,0] op_sel_hi:[1,1,1]
  v_pk_fma_f32 v[130:131], v[26:27], v[46:47], v[130:131] op_sel:[0,1,0] op_sel_hi:[1,1,1]
  v_pk_mul_f32 v[112:113], v[112:113], v[50:51] op_sel:[0,1] op_sel_hi:[1,1]
  v_pk_mul_f32 v[114:115], v[114:115], v[50:51] op_sel:[0,1] op_sel_hi:[1,1]
  v_pk_mul_f32 v[128:129], v[128:129], v[50:51] op_sel:[0,1] op_sel_hi:[1,1]
  v_pk_mul_f32 v[130:131], v[130:131], v[50:51] op_sel:[0,1] op_sel_hi:[1,1]
  v_cvt_pk_bf16_f32 v72, v112, v113
  v_cvt_pk_bf16_f32 v73, v114, v115
  v_cvt_pk_bf16_f32 v74, v128, v129
  v_cvt_pk_bf16_f32 v75, v130, v131
  v_pk_max_i16 v72, v72, 0
  v_pk_max_i16 v73, v73, 0
  v_pk_max_i16 v74, v74, 0
  v_pk_max_i16 v75, v75, 0
  buffer_store_dwordx4 v[72:75], v238, s[36:39], s87 offen sc1
  s_waitcnt lgkmcnt(0)
  v_pk_add_f32 v[28:29], v[28:29], v[204:205]
  v_pk_add_f32 v[30:31], v[30:31], v[206:207]
  v_pk_add_f32 v[32:33], v[32:33], v[208:209]
  v_pk_add_f32 v[34:35], v[34:35], v[210:211]
  v_pk_fma_f32 v[132:133], v[28:29], v[44:45], v[132:133] op_sel:[0,0,0] op_sel_hi:[1,0,1]
  v_pk_fma_f32 v[134:135], v[30:31], v[44:45], v[134:135] op_sel:[0,0,0] op_sel_hi:[1,0,1]
  v_pk_fma_f32 v[148:149], v[32:33], v[44:45], v[148:149] op_sel:[0,0,0] op_sel_hi:[1,0,1]
  v_pk_fma_f32 v[150:151], v[34:35], v[44:45], v[150:151] op_sel:[0,0,0] op_sel_hi:[1,0,1]
  v_pk_mul_f32 v[132:133], v[132:133], v[48:49] op_sel:[0,0] op_sel_hi:[1,0]
  v_pk_mul_f32 v[134:135], v[134:135], v[48:49] op_sel:[0,0] op_sel_hi:[1,0]
  v_pk_mul_f32 v[148:149], v[148:149], v[48:49] op_sel:[0,0] op_sel_hi:[1,0]
  v_pk_mul_f32 v[150:151], v[150:151], v[48:49] op_sel:[0,0] op_sel_hi:[1,0]
  v_cvt_pk_bf16_f32 v60, v132, v133
  v_cvt_pk_bf16_f32 v61, v134, v135
  v_cvt_pk_bf16_f32 v62, v148, v149
  v_cvt_pk_bf16_f32 v63, v150, v151
  v_pk_max_i16 v60, v60, 0
  v_pk_max_i16 v61, v61, 0
  v_pk_max_i16 v62, v62, 0
  v_pk_max_i16 v63, v63, 0
  buffer_store_dwordx4 v[60:63], v239, s[36:39], s84 offen sc1
  v_pk_fma_f32 v[136:137], v[28:29], v[44:45], v[136:137] op_sel:[0,1,0] op_sel_hi:[1,1,1]
  v_pk_fma_f32 v[138:139], v[30:31], v[44:45], v[138:139] op_sel:[0,1,0] op_sel_hi:[1,1,1]
  v_pk_fma_f32 v[152:153], v[32:33], v[44:45], v[152:153] op_sel:[0,1,0] op_sel_hi:[1,1,1]
  v_pk_fma_f32 v[154:155], v[34:35], v[44:45], v[154:155] op_sel:[0,1,0] op_sel_hi:[1,1,1]
  v_pk_mul_f32 v[136:137], v[136:137], v[48:49] op_sel:[0,1] op_sel_hi:[1,1]
  v_pk_mul_f32 v[138:139], v[138:139], v[48:49] op_sel:[0,1] op_sel_hi:[1,1]
  v_pk_mul_f32 v[152:153], v[152:153], v[48:49] op_sel:[0,1] op_sel_hi:[1,1]
  v_pk_mul_f32 v[154:155], v[154:155], v[48:49] op_sel:[0,1] op_sel_hi:[1,1]
  v_cvt_pk_bf16_f32 v64, v136, v137
  v_cvt_pk_bf16_f32 v65, v138, v139
  v_cvt_pk_bf16_f32 v66, v152, v153
  v_cvt_pk_bf16_f32 v67, v154, v155
  v_pk_max_i16 v64, v64, 0
  v_pk_max_i16 v65, v65, 0
  v_pk_max_i16 v66, v66, 0
  v_pk_max_i16 v67, v67, 0
  buffer_store_dwordx4 v[64:67], v239, s[36:39], s85 offen sc1
  v_pk_fma_f32 v[140:141], v[28:29], v[46:47], v[140:141] op_sel:[0,0,0] op_sel_hi:[1,0,1]
  v_pk_fma_f32 v[142:143], v[30:31], v[46:47], v[142:143] op_sel:[0,0,0] op_sel_hi:[1,0,1]
  v_pk_fma_f32 v[156:157], v[32:33], v[46:47], v[156:157] op_sel:[0,0,0] op_sel_hi:[1,0,1]
  v_pk_fma_f32 v[158:159], v[34:35], v[46:47], v[158:159] op_sel:[0,0,0] op_sel_hi:[1,0,1]
  v_pk_mul_f32 v[140:141], v[140:141], v[50:51] op_sel:[0,0] op_sel_hi:[1,0]
  v_pk_mul_f32 v[142:143], v[142:143], v[50:51] op_sel:[0,0] op_sel_hi:[1,0]
  v_pk_mul_f32 v[156:157], v[156:157], v[50:51] op_sel:[0,0] op_sel_hi:[1,0]
  v_pk_mul_f32 v[158:159], v[158:159], v[50:51] op_sel:[0,0] op_sel_hi:[1,0]
  v_cvt_pk_bf16_f32 v68, v140, v141
  v_cvt_pk_bf16_f32 v69, v142, v143
  v_cvt_pk_bf16_f32 v70, v156, v157
  v_cvt_pk_bf16_f32 v71, v158, v159
  v_pk_max_i16 v68, v68, 0
  v_pk_max_i16 v69, v69, 0
  v_pk_max_i16 v70, v70, 0
  v_pk_max_i16 v71, v71, 0
  buffer_store_dwordx4 v[68:71], v239, s[36:39], s86 offen sc1
  v_pk_fma_f32 v[144:145], v[28:29], v[46:47], v[144:145] op_sel:[0,1,0] op_sel_hi:[1,1,1]
  v_pk_fma_f32 v[146:147], v[30:31], v[46:47], v[146:147] op_sel:[0,1,0] op_sel_hi:[1,1,1]
  v_pk_fma_f32 v[160:161], v[32:33], v[46:47], v[160:161] op_sel:[0,1,0] op_sel_hi:[1,1,1]
  v_pk_fma_f32 v[162:163], v[34:35], v[46:47], v[162:163] op_sel:[0,1,0] op_sel_hi:[1,1,1]
  v_pk_mul_f32 v[144:145], v[144:145], v[50:51] op_sel:[0,1] op_sel_hi:[1,1]
  v_pk_mul_f32 v[146:147], v[146:147], v[50:51] op_sel:[0,1] op_sel_hi:[1,1]
  v_pk_mul_f32 v[160:161], v[160:161], v[50:51] op_sel:[0,1] op_sel_hi:[1,1]
  v_pk_mul_f32 v[162:163], v[162:163], v[50:51] op_sel:[0,1] op_sel_hi:[1,1]
  v_cvt_pk_bf16_f32 v72, v144, v145
  v_cvt_pk_bf16_f32 v73, v146, v147
  v_cvt_pk_bf16_f32 v74, v160, v161
  v_cvt_pk_bf16_f32 v75, v162, v163
  v_pk_max_i16 v72, v72, 0
  v_pk_max_i16 v73, v73, 0
  v_pk_max_i16 v74, v74, 0
  v_pk_max_i16 v75, v75, 0
  buffer_store_dwordx4 v[72:75], v239, s[36:39], s87 offen sc1
  v_pk_add_f32 v[36:37], v[36:37], v[212:213]
  v_pk_add_f32 v[38:39], v[38:39], v[214:215]
  v_pk_add_f32 v[40:41], v[40:41], v[216:217]
  v_pk_add_f32 v[42:43], v[42:43], v[218:219]
  v_pk_fma_f32 v[164:165], v[36:37], v[44:45], v[164:165] op_sel:[0,0,0] op_sel_hi:[1,0,1]
  v_pk_fma_f32 v[166:167], v[38:39], v[44:45], v[166:167] op_sel:[0,0,0] op_sel_hi:[1,0,1]
  v_pk_fma_f32 v[180:181], v[40:41], v[44:45], v[180:181] op_sel:[0,0,0] op_sel_hi:[1,0,1]
  v_pk_fma_f32 v[182:183], v[42:43], v[44:45], v[182:183] op_sel:[0,0,0] op_sel_hi:[1,0,1]
  v_pk_mul_f32 v[164:165], v[164:165], v[48:49] op_sel:[0,0] op_sel_hi:[1,0]
  v_pk_mul_f32 v[166:167], v[166:167], v[48:49] op_sel:[0,0] op_sel_hi:[1,0]
  v_pk_mul_f32 v[180:181], v[180:181], v[48:49] op_sel:[0,0] op_sel_hi:[1,0]
  v_pk_mul_f32 v[182:183], v[182:183], v[48:49] op_sel:[0,0] op_sel_hi:[1,0]
  v_cvt_pk_bf16_f32 v60, v164, v165
  v_cvt_pk_bf16_f32 v61, v166, v167
  v_cvt_pk_bf16_f32 v62, v180, v181
  v_cvt_pk_bf16_f32 v63, v182, v183
  v_pk_max_i16 v60, v60, 0
  v_pk_max_i16 v61, v61, 0
  v_pk_max_i16 v62, v62, 0
  v_pk_max_i16 v63, v63, 0
  buffer_store_dwordx4 v[60:63], v246, s[36:39], s84 offen sc1
  v_pk_fma_f32 v[168:169], v[36:37], v[44:45], v[168:169] op_sel:[0,1,0] op_sel_hi:[1,1,1]
  v_pk_fma_f32 v[170:171], v[38:39], v[44:45], v[170:171] op_sel:[0,1,0] op_sel_hi:[1,1,1]
  v_pk_fma_f32 v[184:185], v[40:41], v[44:45], v[184:185] op_sel:[0,1,0] op_sel_hi:[1,1,1]
  v_pk_fma_f32 v[186:187], v[42:43], v[44:45], v[186:187] op_sel:[0,1,0] op_sel_hi:[1,1,1]
  v_pk_mul_f32 v[168:169], v[168:169], v[48:49] op_sel:[0,1] op_sel_hi:[1,1]
  v_pk_mul_f32 v[170:171], v[170:171], v[48:49] op_sel:[0,1] op_sel_hi:[1,1]
  v_pk_mul_f32 v[184:185], v[184:185], v[48:49] op_sel:[0,1] op_sel_hi:[1,1]
  v_pk_mul_f32 v[186:187], v[186:187], v[48:49] op_sel:[0,1] op_sel_hi:[1,1]
  v_cvt_pk_bf16_f32 v64, v168, v169
  v_cvt_pk_bf16_f32 v65, v170, v171
  v_cvt_pk_bf16_f32 v66, v184, v185
  v_cvt_pk_bf16_f32 v67, v186, v187
  v_pk_max_i16 v64, v64, 0
  v_pk_max_i16 v65, v65, 0
  v_pk_max_i16 v66, v66, 0
  v_pk_max_i16 v67, v67, 0
  buffer_store_dwordx4 v[64:67], v246, s[36:39], s85 offen sc1
  v_pk_fma_f32 v[172:173], v[36:37], v[46:47], v[172:173] op_sel:[0,0,0] op_sel_hi:[1,0,1]
  v_pk_fma_f32 v[174:175], v[38:39], v[46:47], v[174:175] op_sel:[0,0,0] op_sel_hi:[1,0,1]
  v_pk_fma_f32 v[188:189], v[40:41], v[46:47], v[188:189] op_sel:[0,0,0] op_sel_hi:[1,0,1]
  v_pk_fma_f32 v[190:191], v[42:43], v[46:47], v[190:191] op_sel:[0,0,0] op_sel_hi:[1,0,1]
  v_pk_mul_f32 v[172:173], v[172:173], v[50:51] op_sel:[0,0] op_sel_hi:[1,0]
  v_pk_mul_f32 v[174:175], v[174:175], v[50:51] op_sel:[0,0] op_sel_hi:[1,0]
  v_pk_mul_f32 v[188:189], v[188:189], v[50:51] op_sel:[0,0] op_sel_hi:[1,0]
  v_pk_mul_f32 v[190:191], v[190:191], v[50:51] op_sel:[0,0] op_sel_hi:[1,0]
  v_cvt_pk_bf16_f32 v68, v172, v173
  v_cvt_pk_bf16_f32 v69, v174, v175
  v_cvt_pk_bf16_f32 v70, v188, v189
  v_cvt_pk_bf16_f32 v71, v190, v191
  v_pk_max_i16 v68, v68, 0
  v_pk_max_i16 v69, v69, 0
  v_pk_max_i16 v70, v70, 0
  v_pk_max_i16 v71, v71, 0
  buffer_store_dwordx4 v[68:71], v246, s[36:39], s86 offen sc1
  v_pk_fma_f32 v[176:177], v[36:37], v[46:47], v[176:177] op_sel:[0,1,0] op_sel_hi:[1,1,1]
  v_pk_fma_f32 v[178:179], v[38:39], v[46:47], v[178:179] op_sel:[0,1,0] op_sel_hi:[1,1,1]
  v_pk_fma_f32 v[192:193], v[40:41], v[46:47], v[192:193] op_sel:[0,1,0] op_sel_hi:[1,1,1]
  v_pk_fma_f32 v[194:195], v[42:43], v[46:47], v[194:195] op_sel:[0,1,0] op_sel_hi:[1,1,1]
  v_pk_mul_f32 v[176:177], v[176:177], v[50:51] op_sel:[0,1] op_sel_hi:[1,1]
  v_pk_mul_f32 v[178:179], v[178:179], v[50:51] op_sel:[0,1] op_sel_hi:[1,1]
  v_pk_mul_f32 v[192:193], v[192:193], v[50:51] op_sel:[0,1] op_sel_hi:[1,1]
  v_pk_mul_f32 v[194:195], v[194:195], v[50:51] op_sel:[0,1] op_sel_hi:[1,1]
  v_cvt_pk_bf16_f32 v72, v176, v177
  v_cvt_pk_bf16_f32 v73, v178, v179
  v_cvt_pk_bf16_f32 v74, v192, v193
  v_cvt_pk_bf16_f32 v75, v194, v195
  v_pk_max_i16 v72, v72, 0
  v_pk_max_i16 v73, v73, 0
  v_pk_max_i16 v74, v74, 0
  v_pk_max_i16 v75, v75, 0
  buffer_store_dwordx4 v[72:75], v246, s[36:39], s87 offen sc1
  v_and_b32 v5, 7, v1
  v_lshlrev_b32 v5, 7, v5
  v_and_b32 v6, 31, v1
  v_lshlrev_b32 v6, 7, v6
  v_lshrrev_b32 v13, 4, v1
  v_lshlrev_b32 v13, 4, v13
  v_and_b32 v14, 1, v1
  v_lshl_add_u32 v13, v14, 6, v13
  s_waitcnt vmcnt(15)
  s_mov_b32 s71, 0
L_init_top_41:
  v_cmp_ne_u32 vcc, 1, v254
  s_cbranch_vccz L_init_ok_42
  s_sleep 4
  buffer_load_dword v254, v252, s[52:55], 8 offen sc1
  s_add_u32 s71, s71, 1
  s_cmp_lt_u32 s71, 0x20000
  s_waitcnt vmcnt(0)
  s_cbranch_scc1 L_init_top_41
L_init_ok_42:
  ds_read_b64_tr_b16 a[16:17], v11 offset:32768
  ds_read_b64_tr_b16 a[18:19], v11 offset:34816
  ds_read_b64_tr_b16 a[20:21], v12 offset:32768
  ds_read_b64_tr_b16 a[22:23], v12 offset:34816
  ds_read_b64_tr_b16 a[24:25], v11 offset:33280
  ds_read_b64_tr_b16 a[26:27], v11 offset:35328
  ds_read_b64_tr_b16 a[28:29], v12 offset:33280
  ds_read_b64_tr_b16 a[30:31], v12 offset:35328
  v_add_u32 v250, 98304, v11
  v_add_u32 v251, 98304, v12
  ds_read_b64_tr_b16 a[32:33], v250 offset:0
  ds_read_b64_tr_b16 a[34:35], v250 offset:2048
  ds_read_b64_tr_b16 a[36:37], v251 offset:0
  ds_read_b64_tr_b16 a[38:39], v251 offset:2048
  ds_read_b64_tr_b16 a[40:41], v250 offset:512
  ds_read_b64_tr_b16 a[42:43], v250 offset:2560
  ds_read_b64_tr_b16 a[44:45], v251 offset:512
  ds_read_b64_tr_b16 a[46:47], v251 offset:2560
  ds_read_b64_tr_b16 a[48:49], v11 offset:0
  ds_read_b64_tr_b16 a[50:51], v11 offset:2048
  ds_read_b64_tr_b16 a[52:53], v12 offset:0
  ds_read_b64_tr_b16 a[54:55], v12 offset:2048
  ds_read_b64_tr_b16 a[56:57], v11 offset:512
  ds_read_b64_tr_b16 a[58:59], v11 offset:2560
  ds_read_b64_tr_b16 a[60:61], v12 offset:512
  ds_read_b64_tr_b16 a[62:63], v12 offset:2560
  v_add_u32 v250, 122880, v11
  v_add_u32 v251, 122880, v12
  ds_read_b64_tr_b16 a[64:65], v250 offset:0
  ds_read_b64_tr_b16 a[66:67], v250 offset:2048
  ds_read_b64_tr_b16 a[68:69], v251 offset:0
  ds_read_b64_tr_b16 a[70:71], v251 offset:2048
  ds_read_b64_tr_b16 a[72:73], v250 offset:512
  ds_read_b64_tr_b16 a[74:75], v250 offset:2560
  ds_read_b64_tr_b16 a[76:77], v251 offset:512
  ds_read_b64_tr_b16 a[78:79], v251 offset:2560
  v_mov_b32 v7, 1
  v_mov_b32 v14, 0
  s_waitcnt vmcnt(0) lgkmcnt(0)
  s_barrier
  s_cmp_lg_u32 s24, 0
  s_cbranch_scc1 L_pub_43
  buffer_store_dword v7, v14, s[36:39], s0 offen sc1
L_pub_43:
  s_add_u32 m0, s70, 52224
  s_add_u32 s4, s3, 24576
  buffer_load_dwordx4 v10, s[40:43], s4 offen lds
  s_lshl_b32 s3, s11, 5
  s_add_u32 m0, s70, 139264
  s_add_u32 s4, s3, 0
  buffer_load_dwordx4 v10, s[40:43], s4 offen lds
  s_add_u32 m0, s70, 140288
  s_add_u32 s4, s3, 8192
  buffer_load_dwordx4 v10, s[40:43], s4 offen lds
  s_add_u32 m0, s70, 141312
  s_add_u32 s4, s3, 16384
  buffer_load_dwordx4 v10, s[40:43], s4 offen lds
  s_add_u32 m0, s70, 142336
  s_add_u32 s4, s3, 24576
  buffer_load_dwordx4 v10, s[40:43], s4 offen lds
  s_lshl_b32 s3, s17, 5
  s_add_u32 m0, s70, 16384
  s_add_u32 s4, s3, 0
  buffer_load_dwordx4 v10, s[44:47], s4 offen lds
  s_add_u32 m0, s70, 17408
  s_add_u32 s4, s3, 8192
  buffer_load_dwordx4 v10, s[44:47], s4 offen lds
  s_add_u32 m0, s70, 18432
  s_add_u32 s4, s3, 16384
  buffer_load_dwordx4 v10, s[44:47], s4 offen lds
  s_add_u32 m0, s70, 19456
  s_add_u32 s4, s3, 24576
  buffer_load_dwordx4 v10, s[44:47], s4 offen lds
  s_lshl_b32 s3, s12, 5
  s_add_u32 m0, s70, 65536
  s_add_u32 s4, s3, 0
  buffer_load_dwordx4 v10, s[40:43], s4 offen lds
  s_add_u32 m0, s70, 66560
  s_add_u32 s4, s3, 8192
  buffer_load_dwordx4 v10, s[40:43], s4 offen lds
  s_add_u32 m0, s70, 67584
  s_add_u32 s4, s3, 16384
  buffer_load_dwordx4 v10, s[40:43], s4 offen lds
  s_add_u32 m0, s70, 68608
  s_add_u32 s4, s3, 24576
  buffer_load_dwordx4 v10, s[40:43], s4 offen lds
  s_lshl_b32 s3, s13, 5
  s_add_u32 m0, s70, 81920
  s_add_u32 s4, s3, 0
  buffer_load_dwordx4 v10, s[40:43], s4 offen lds
  s_add_u32 m0, s70, 82944
  s_add_u32 s4, s3, 8192
  buffer_load_dwordx4 v10, s[40:43], s4 offen lds
  s_add_u32 m0, s70, 83968
  s_add_u32 s4, s3, 16384
  buffer_load_dwordx4 v10, s[40:43], s4 offen lds
  s_add_u32 m0, s70, 84992
  s_add_u32 s4, s3, 24576
  buffer_load_dwordx4 v10, s[40:43], s4 offen lds
  s_lshl_b32 s3, s18, 5
  s_add_u32 m0, s70, 32768
  s_add_u32 s4, s3, 0
  buffer_load_dwordx4 v10, s[44:47], s4 offen lds
  s_add_u32 m0, s70, 33792
  s_add_u32 s4, s3, 8192
  buffer_load_dwordx4 v10, s[44:47], s4 offen lds
  s_add_u32 m0, s70, 34816
  s_add_u32 s4, s3, 16384
  buffer_load_dwordx4 v10, s[44:47], s4 offen lds
  s_add_u32 m0, s70, 35840
  s_add_u32 s4, s3, 24576
  buffer_load_dwordx4 v10, s[44:47], s4 offen lds
  s_cmp_lg_u32 s24, 0
  s_cbranch_scc1 L_poll_44
  buffer_load_dword v7, v5, s[36:39], s90 offen sc1
L_poll_44:
  s_lshl_b32 s3, s14, 5
  s_add_u32 m0, s70, 98304
  s_add_u32 s4, s3, 0
  buffer_load_dwordx4 v10, s[40:43], s4 offen lds
  s_add_u32 m0, s70, 99328
  s_add_u32 s4, s3, 8192
  buffer_load_dwordx4 v10, s[40:43], s4 offen lds
  s_add_u32 m0, s70, 100352
  s_add_u32 s4, s3, 16384
  buffer_load_dwordx4 v10, s[40:43], s4 offen lds
  s_add_u32 m0, s70, 101376
  s_add_u32 s4, s3, 24576
  buffer_load_dwordx4 v10, s[40:43], s4 offen lds
  s_lshl_b32 s3, s15, 5
  s_add_u32 m0, s70, 0
  s_add_u32 s4, s3, 0
  buffer_load_dwordx4 v10, s[40:43], s4 offen lds
  s_add_u32 m0, s70, 1024
  s_add_u32 s4, s3, 8192
  buffer_load_dwordx4 v10, s[40:43], s4 offen lds
  s_add_u32 m0, s70, 2048
  s_add_u32 s4, s3, 16384
  buffer_load_dwordx4 v10, s[40:43], s4 offen lds
  s_add_u32 m0, s70, 3072
  s_add_u32 s4, s3, 24576
  buffer_load_dwordx4 v10, s[40:43], s4 offen lds
  s_lshl_b32 s3, s19, 5
  s_add_u32 m0, s70, 122880
  s_add_u32 s4, s3, 0
  buffer_load_dwordx4 v10, s[44:47], s4 offen lds
  s_add_u32 m0, s70, 123904
  s_add_u32 s4, s3, 8192
  buffer_load_dwordx4 v10, s[44:47], s4 offen lds
  s_add_u32 m0, s70, 124928
  s_add_u32 s4, s3, 16384
  buffer_load_dwordx4 v10, s[44:47], s4 offen lds
  s_add_u32 m0, s70, 125952
  s_add_u32 s4, s3, 24576
  buffer_load_dwordx4 v10, s[44:47], s4 offen lds
  s_min_u32 s5, s5, 43008
  s_add_u32 s5, s5, s92
  s_min_u32 s6, s6, 43008
  s_add_u32 s6, s6, s92
  s_min_u32 s7, s7, 43008
  s_add_u32 s7, s7, s92
  s_min_u32 s8, s8, 43008
  s_add_u32 s8, s8, s92
  s_min_u32 s9, s9, 43008
  s_add_u32 s9, s9, s92
  s_min_u32 s10, s10, 43008
  s_add_u32 s10, s10, s92
  s_min_u32 s11, s11, 43008
  s_add_u32 s11, s11, s92
  s_min_u32 s12, s12, 43008
  s_add_u32 s12, s12, s92
  s_min_u32 s13, s13, 43008
  s_add_u32 s13, s13, s92
  s_min_u32 s14, s14, 43008
  s_add_u32 s14, s14, s92
  s_min_u32 s15, s15, 43008
  s_add_u32 s15, s15, s92
  s_waitcnt vmcnt(12)
L_p2:
  v_lshlrev_b32 v252, 4, v1
  s_add_u32 s72, s24, 1
  s_and_b32 s72, s72, 3
  s_mul_i32 s74, s72, 12288
  s_mul_i32 s72, s72, 61440
  v_add_u32 v236, s72, v252
  s_add_u32 s72, s24, 2
  s_and_b32 s72, s72, 3
  s_mul_i32 s75, s72, 12288
  s_mul_i32 s72, s72, 61440
  v_add_u32 v237, s72, v252
  s_add_u32 s72, s24, 3
  s_and_b32 s72, s72, 3
  s_mul_i32 s76, s72, 12288
  s_mul_i32 s72, s72, 61440
  v_add_u32 v238, s72, v252
  s_add_u32 s72, s24, 4
  s_and_b32 s72, s72, 3
  s_mul_i32 s77, s72, 12288
  s_mul_i32 s72, s72, 61440
  v_add_u32 v239, s72, v252
  v_add_u32 v248, 49152, v11
  v_add_u32 v249, 49152, v12
  ds_read_b64_tr_b16 a[80:81], v248 offset:0
  ds_read_b64_tr_b16 a[82:83], v248 offset:2048
  ds_read_b64_tr_b16 a[84:85], v249 offset:0
  ds_read_b64_tr_b16 a[86:87], v249 offset:2048
  ds_read_b64_tr_b16 a[88:89], v248 offset:512
  ds_read_b64_tr_b16 a[90:91], v248 offset:2560
  ds_read_b64_tr_b16 a[92:93], v249 offset:512
  ds_read_b64_tr_b16 a[94:95], v249 offset:2560
  v_add_u32 v250, 139264, v11
  v_add_u32 v251, 139264, v12
  ds_read_b64_tr_b16 a[96:97], v250 offset:0
  ds_read_b64_tr_b16 a[98:99], v250 offset:2048
  ds_read_b64_tr_b16 a[100:101], v251 offset:0
  ds_read_b64_tr_b16 a[102:103], v251 offset:2048
  ds_read_b64_tr_b16 a[104:105], v250 offset:512
  ds_read_b64_tr_b16 a[106:107], v250 offset:2560
  ds_read_b64_tr_b16 a[108:109], v251 offset:512
  ds_read_b64_tr_b16 a[110:111], v251 offset:2560
  s_mov_b32 s71, 0
L_fl_top_45:
  v_cmp_ne_u32 vcc, 1, v7
  s_cbranch_vccz L_fl_ok_46
  s_sleep 4
  buffer_load_dword v7, v5, s[36:39], s90 offen sc1
  s_add_u32 s71, s71, 1
  s_cmp_lt_u32 s71, 0x20000
  s_waitcnt vmcnt(0)
  s_cbranch_scc1 L_fl_top_45
L_fl_ok_46:
  s_barrier
  buffer_load_dwordx4 v[80:83], v236, s[36:39], s5 offen sc1
  buffer_load_dwordx4 v[84:87], v237, s[36:39], s5 offen sc1
  buffer_load_dwordx4 v[88:91], v238, s[36:39], s5 offen sc1
  buffer_load_dwordx4 v[92:95], v239, s[36:39], s5 offen sc1
  buffer_load_dwordx4 v[96:99], v236, s[36:39], s6 offen sc1
  buffer_load_dwordx4 v[100:103], v237, s[36:39], s6 offen sc1
  buffer_load_dwordx4 v[104:107], v238, s[36:39], s6 offen sc1
  buffer_load_dwordx4 v[108:111], v239, s[36:39], s6 offen sc1
  s_add_u32 s78, s92, 44032
  s_add_u32 s72, s74, 0
  v_add_u32 v2, s72, v252
  s_add_u32 s72, s75, 4096
  v_add_u32 v3, s72, v252
  s_add_u32 s72, s76, 8192
  v_add_u32 v4, s72, v252
  s_mul_i32 s72, s24, 12288
  v_add_u32 v8, s72, v252
  v_and_b32 v9, 15, v1
  v_lshlrev_b32 v9, 10, v9
  v_lshrrev_b32 v14, 4, v1
  v_and_b32 v15, 1, v14
  v_lshl_add_u32 v15, v15, 5, v9
  v_lshrrev_b32 v14, 1, v14
  v_lshl_add_u32 v15, v14, 4, v15
  s_waitcnt vmcnt(8)
  ds_read_b64_tr_b16 a[192:193], v11 offset:16384
  ds_read_b64_tr_b16 a[194:195], v11 offset:18432
  ds_read_b64_tr_b16 a[196:197], v12 offset:16384
  ds_read_b64_tr_b16 a[198:199], v12 offset:18432
  ds_read_b64_tr_b16 a[200:201], v11 offset:16896
  ds_read_b64_tr_b16 a[202:203], v11 offset:18944
  ds_read_b64_tr_b16 a[204:205], v12 offset:16896
  ds_read_b64_tr_b16 a[206:207], v12 offset:18944
  v_add_u32 v250, 65536, v11
  v_add_u32 v251, 65536, v12
  ds_read_b64_tr_b16 a[112:113], v250 offset:0
  ds_read_b64_tr_b16 a[114:115], v250 offset:2048
  ds_read_b64_tr_b16 a[116:117], v251 offset:0
  ds_read_b64_tr_b16 a[118:119], v251 offset:2048
  ds_read_b64_tr_b16 a[120:121], v250 offset:512
  ds_read_b64_tr_b16 a[122:123], v250 offset:2560
  ds_read_b64_tr_b16 a[124:125], v251 offset:512
  ds_read_b64_tr_b16 a[126:127], v251 offset:2560
  v_add_u32 v248, 81920, v11
  v_add_u32 v249, 81920, v12
  ds_read_b64_tr_b16 a[128:129], v248 offset:0
  ds_read_b64_tr_b16 a[130:131], v248 offset:2048
  ds_read_b64_tr_b16 a[132:133], v249 offset:0
  ds_read_b64_tr_b16 a[134:135], v249 offset:2048
  ds_read_b64_tr_b16 a[136:137], v248 offset:512
  ds_read_b64_tr_b16 a[138:139], v248 offset:2560
  ds_read_b64_tr_b16 a[140:141], v249 offset:512
  ds_read_b64_tr_b16 a[142:143], v249 offset:2560
  ds_read_b64_tr_b16 a[208:209], v11 offset:32768
  ds_read_b64_tr_b16 a[210:211], v11 offset:34816
  ds_read_b64_tr_b16 a[212:213], v12 offset:32768
  ds_read_b64_tr_b16 a[214:215], v12 offset:34816
  ds_read_b64_tr_b16 a[216:217], v11 offset:33280
  ds_read_b64_tr_b16 a[218:219], v11 offset:35328
  ds_read_b64_tr_b16 a[220:221], v12 offset:33280
  ds_read_b64_tr_b16 a[222:223], v12 offset:35328
  v_add_u32 v248, 98304, v11
  v_add_u32 v249, 98304, v12
  ds_read_b64_tr_b16 a[144:145], v248 offset:0
  ds_read_b64_tr_b16 a[146:147], v248 offset:2048
  ds_read_b64_tr_b16 a[148:149], v249 offset:0
  ds_read_b64_tr_b16 a[150:151], v249 offset:2048
  ds_read_b64_tr_b16 a[152:153], v248 offset:512
  ds_read_b64_tr_b16 a[154:155], v248 offset:2560
  ds_read_b64_tr_b16 a[156:157], v249 offset:512
  ds_read_b64_tr_b16 a[158:159], v249 offset:2560
  ds_read_b64_tr_b16 a[160:161], v11 offset:0
  ds_read_b64_tr_b16 a[162:163], v11 offset:2048
  ds_read_b64_tr_b16 a[164:165], v12 offset:0
  ds_read_b64_tr_b16 a[166:167], v12 offset:2048
  ds_read_b64_tr_b16 a[168:169], v11 offset:512
  ds_read_b64_tr_b16 a[170:171], v11 offset:2560
  ds_read_b64_tr_b16 a[172:173], v12 offset:512
  ds_read_b64_tr_b16 a[174:175], v12 offset:2560
  v_add_u32 v248, 122880, v11
  v_add_u32 v249, 122880, v12
  ds_read_b64_tr_b16 a[224:225], v248 offset:0
  ds_read_b64_tr_b16 a[226:227], v248 offset:2048
  ds_read_b64_tr_b16 a[228:229], v249 offset:0
  ds_read_b64_tr_b16 a[230:231], v249 offset:2048
  ds_read_b64_tr_b16 a[232:233], v248 offset:512
  ds_read_b64_tr_b16 a[234:235], v248 offset:2560
  ds_read_b64_tr_b16 a[236:237], v249 offset:512
  ds_read_b64_tr_b16 a[238:239], v249 offset:2560
  v_and_b32 v9, 15, v1
  v_lshlrev_b32 v9, 7, v9
  v_lshrrev_b32 v14, 4, v1
  v_lshl_add_u32 v9, v14, 3, v9
  s_lshl_b32 s72, s24, 11
  s_add_u32 s72, s72, 114688
  v_add_u32 v9, s72, v9
  ds_read_b64 v[240:241], v9 offset:0
  ds_read_b64 v[242:243], v9 offset:32
  ds_read_b64 v[244:245], v9 offset:64
  ds_read_b64 v[246:247], v9 offset:96
  buffer_load_dword v7, v6, s[36:39], s91 offen sc1
  buffer_load_dwordx4 v[112:115], v236, s[36:39], s7 offen sc1
  buffer_load_dwordx4 v[116:119], v237, s[36:39], s7 offen sc1
  buffer_load_dwordx4 v[120:123], v238, s[36:39], s7 offen sc1
  buffer_load_dwordx4 v[124:127], v239, s[36:39], s7 offen sc1
  s_waitcnt vmcnt(9) lgkmcnt(0)
  v_mfma_f32_16x16x32_bf16 v[16:19], a[0:3], v[80:83], 0
  buffer_load_dwordx4 v[128:131], v236, s[36:39], s8 offen sc1
  v_mfma_f32_16x16x32_bf16 v[20:23], a[0:3], v[84:87], 0
  v_mfma_f32_16x16x32_bf16 v[24:27], a[0:3], v[88:91], 0
  v_mfma_f32_16x16x32_bf16 v[28:31], a[0:3], v[92:95], 0
  v_mfma_f32_16x16x32_bf16 v[32:35], a[4:7], v[80:83], 0
  buffer_load_dwordx4 v[132:135], v237, s[36:39], s8 offen sc1
  v_mfma_f32_16x16x32_bf16 v[36:39], a[4:7], v[84:87], 0
  v_mfma_f32_16x16x32_bf16 v[40:43], a[4:7], v[88:91], 0
  v_mfma_f32_16x16x32_bf16 v[44:47], a[4:7], v[92:95], 0
  v_mfma_f32_16x16x32_bf16 v[48:51], a[8:11], v[80:83], 0
  buffer_load_dwordx4 v[136:139], v238, s[36:39], s8 offen sc1
  v_mfma_f32_16x16x32_bf16 v[52:55], a[8:11], v[84:87], 0
  v_mfma_f32_16x16x32_bf16 v[56:59], a[8:11], v[88:91], 0
  v_mfma_f32_16x16x32_bf16 v[60:63], a[8:11], v[92:95], 0
  v_mfma_f32_16x16x32_bf16 v[64:67], a[12:15], v[80:83], 0
  buffer_load_dwordx4 v[140:143], v239, s[36:39], s8 offen sc1
  v_mfma_f32_16x16x32_bf16 v[68:71], a[12:15], v[84:87], 0
  v_mfma_f32_16x16x32_bf16 v[72:75], a[12:15], v[88:91], 0
  v_mfma_f32_16x16x32_bf16 v[76:79], a[12:15], v[92:95], 0
  s_waitcnt vmcnt(9) lgkmcnt(0)
  s_waitcnt vmcnt(8)
  s_mov_b32 s71, 0
L_fq_top_47:
  v_cmp_ne_u32 vcc, 1, v7
  s_cbranch_vccz L_fq_ok_48
  s_sleep 4
  buffer_load_dword v7, v6, s[36:39], s91 offen sc1
  s_add_u32 s71, s71, 1
  s_cmp_lt_u32 s71, 0x20000
  s_waitcnt vmcnt(0)
  s_cbranch_scc1 L_fq_top_47
L_fq_ok_48:
  v_mfma_f32_16x16x32_bf16 v[16:19], a[16:19], v[96:99], v[16:19]
  s_lshl_b32 s3, s16, 1
  s_add_u32 s3, s3, 8388608
  v_mfma_f32_16x16x32_bf16 v[20:23], a[16:19], v[100:103], v[20:23]
  buffer_load_dwordx4 v[176:179], v252, s[36:39], s3 offen offset:0 sc1
  buffer_load_dwordx4 v[180:183], v252, s[36:39], s3 offen offset:1024 sc1
  v_mfma_f32_16x16x32_bf16 v[24:27], a[16:19], v[104:107], v[24:27]
  s_lshr_b32 s4, s16, 3
  s_add_u32 s4, s4, 8421376
  v_mfma_f32_16x16x32_bf16 v[28:31], a[16:19], v[108:111], v[28:31]
  buffer_load_dwordx4 v[208:211], v13, s[36:39], s4 offen sc1
  v_mfma_f32_16x16x32_bf16 v[32:35], a[20:23], v[96:99], v[32:35]
  s_lshl_b32 s3, s17, 1
  s_add_u32 s3, s3, 8388608
  v_mfma_f32_16x16x32_bf16 v[36:39], a[20:23], v[100:103], v[36:39]
  buffer_load_dwordx4 v[184:187], v252, s[36:39], s3 offen offset:0 sc1
  buffer_load_dwordx4 v[188:191], v252, s[36:39], s3 offen offset:1024 sc1
  v_mfma_f32_16x16x32_bf16 v[40:43], a[20:23], v[104:107], v[40:43]
  s_lshr_b32 s4, s17, 3
  s_add_u32 s4, s4, 8421376
  v_mfma_f32_16x16x32_bf16 v[44:47], a[20:23], v[108:111], v[44:47]
  buffer_load_dwordx4 v[212:215], v13, s[36:39], s4 offen sc1
  v_mfma_f32_16x16x32_bf16 v[48:51], a[24:27], v[96:99], v[48:51]
  s_lshl_b32 s3, s18, 1
  s_add_u32 s3, s3, 8388608
  v_mfma_f32_16x16x32_bf16 v[52:55], a[24:27], v[100:103], v[52:55]
  buffer_load_dwordx4 v[192:195], v252, s[36:39], s3 offen offset:0 sc1
  buffer_load_dwordx4 v[196:199], v252, s[36:39], s3 offen offset:1024 sc1
  v_mfma_f32_16x16x32_bf16 v[56:59], a[24:27], v[104:107], v[56:59]
  s_lshr_b32 s4, s18, 3
  s_add_u32 s4, s4, 8421376
  v_mfma_f32_16x16x32_bf16 v[60:63], a[24:27], v[108:111], v[60:63]
  buffer_load_dwordx4 v[216:219], v13, s[36:39], s4 offen sc1
  v_mfma_f32_16x16x32_bf16 v[64:67], a[28:31], v[96:99], v[64:67]
  s_lshl_b32 s3, s19, 1
  s_add_u32 s3, s3, 8388608
  v_mfma_f32_16x16x32_bf16 v[68:71], a[28:31], v[100:103], v[68:71]
  buffer_load_dwordx4 v[200:203], v252, s[36:39], s3 offen offset:0 sc1
  buffer_load_dwordx4 v[204:207], v252, s[36:39], s3 offen offset:1024 sc1
  v_mfma_f32_16x16x32_bf16 v[72:75], a[28:31], v[104:107], v[72:75]
  s_lshr_b32 s4, s19, 3
  s_add_u32 s4, s4, 8421376
  v_mfma_f32_16x16x32_bf16 v[76:79], a[28:31], v[108:111], v[76:79]
  buffer_load_dwordx4 v[220:223], v13, s[36:39], s4 offen sc1
  s_waitcnt vmcnt(16) lgkmcnt(0)
  v_mfma_f32_16x16x32_bf16 v[16:19], a[32:35], v[112:115], v[16:19]
  s_add_u32 s3, s16, s78
  v_mfma_f32_16x16x32_bf16 v[20:23], a[32:35], v[116:119], v[20:23]
  buffer_load_dwordx4 v[144:147], v236, s[36:39], s3 offen sc1
  v_mfma_f32_16x16x32_bf16 v[24:27], a[32:35], v[120:123], v[24:27]
  buffer_load_dwordx4 v[148:151], v237, s[36:39], s3 offen sc1
  v_mfma_f32_16x16x32_bf16 v[28:31], a[32:35], v[124:127], v[28:31]
  v_mfma_f32_16x16x32_bf16 v[32:35], a[36:39], v[112:115], v[32:35]
  buffer_load_dwordx4 v[152:155], v238, s[36:39], s3 offen sc1
  v_mfma_f32_16x16x32_bf16 v[36:39], a[36:39], v[116:119], v[36:39]
  v_mfma_f32_16x16x32_bf16 v[40:43], a[36:39], v[120:123], v[40:43]
  buffer_load_dwordx4 v[156:159], v239, s[36:39], s3 offen sc1
  v_mfma_f32_16x16x32_bf16 v[44:47], a[36:39], v[124:127], v[44:47]
  v_mfma_f32_16x16x32_bf16 v[48:51], a[40:43], v[112:115], v[48:51]
  buffer_load_dwordx4 v[160:163], v236, s[36:39], s9 offen sc1
  v_mfma_f32_16x16x32_bf16 v[52:55], a[40:43], v[116:119], v[52:55]
  v_mfma_f32_16x16x32_bf16 v[56:59], a[40:43], v[120:123], v[56:59]
  buffer_load_dwordx4 v[164:167], v237, s[36:39], s9 offen sc1
  v_mfma_f32_16x16x32_bf16 v[60:63], a[40:43], v[124:127], v[60:63]
  v_mfma_f32_16x16x32_bf16 v[64:67], a[44:47], v[112:115], v[64:67]
  buffer_load_dwordx4 v[168:171], v238, s[36:39], s9 offen sc1
  v_mfma_f32_16x16x32_bf16 v[68:71], a[44:47], v[116:119], v[68:71]
  v_mfma_f32_16x16x32_bf16 v[72:75], a[44:47], v[120:123], v[72:75]
  buffer_load_dwordx4 v[172:175], v239, s[36:39], s9 offen sc1
  v_mfma_f32_16x16x32_bf16 v[76:79], a[44:47], v[124:127], v[76:79]
  s_waitcnt vmcnt(20) lgkmcnt(0)
  s_waitcnt vmcnt(8)
  v_mfma_f32_16x16x32_bf16 v[16:19], a[48:51], v[128:131], v[16:19]
  v_and_b32 v14, 1, v1
  s_add_u32 s3, s17, s78
  v_cmp_eq_u32 vcc, 0, v14
  v_cvt_pk_bf16_f32 v224, v176, v177
  v_mfma_f32_16x16x32_bf16 v[20:23], a[48:51], v[132:135], v[20:23]
  v_cvt_pk_bf16_f32 v225, v178, v179
  v_cvt_pk_bf16_f32 v226, v180, v181
  v_cvt_pk_bf16_f32 v227, v182, v183
  v_mfma_f32_16x16x32_bf16 v[24:27], a[48:51], v[136:139], v[24:27]
  v_cvt_pk_bf16_f32 v228, v184, v185
  v_cvt_pk_bf16_f32 v229, v186, v187
  v_cvt_pk_bf16_f32 v230, v188, v189
  v_mfma_f32_16x16x32_bf16 v[28:31], a[48:51], v[140:143], v[28:31]
  v_cvt_pk_bf16_f32 v231, v190, v191
  buffer_load_dwordx4 v[80:83], v236, s[36:39], s3 offen sc1
  v_cvt_pk_bf16_f32 v232, v192, v193
  v_mfma_f32_16x16x32_bf16 v[32:35], a[52:55], v[128:131], v[32:35]
  v_cvt_pk_bf16_f32 v233, v194, v195
  v_cvt_pk_bf16_f32 v234, v196, v197
  v_cvt_pk_bf16_f32 v235, v198, v199
  v_mfma_f32_16x16x32_bf16 v[36:39], a[52:55], v[132:135], v[36:39]
  v_cvt_pk_bf16_f32 v248, v200, v201
  v_cvt_pk_bf16_f32 v249, v202, v203
  v_cvt_pk_bf16_f32 v250, v204, v205
  v_cvt_pk_bf16_f32 v251, v206, v207
  v_mfma_f32_16x16x32_bf16 v[40:43], a[52:55], v[136:139], v[40:43]
  v_cvt_pk_bf16_f32 v208, v208, v209
  buffer_load_dwordx4 v[84:87], v237, s[36:39], s3 offen sc1
  v_cvt_pk_bf16_f32 v209, v210, v211
  v_mfma_f32_16x16x32_bf16 v[44:47], a[52:55], v[140:143], v[44:47]
  v_cndmask_b32 v176, 0, v208, vcc
  v_cndmask_b32 v178, v208, 0, vcc
  v_cndmask_b32 v177, 0, v209, vcc
  v_mfma_f32_16x16x32_bf16 v[48:51], a[56:59], v[128:131], v[48:51]
  v_cndmask_b32 v179, v209, 0, vcc
  v_cvt_pk_bf16_f32 v212, v212, v213
  v_cvt_pk_bf16_f32 v213, v214, v215
  v_mfma_f32_16x16x32_bf16 v[52:55], a[56:59], v[132:135], v[52:55]
  v_cndmask_b32 v180, 0, v212, vcc
  v_cndmask_b32 v182, v212, 0, vcc
  buffer_load_dwordx4 v[88:91], v238, s[36:39], s3 offen sc1
  v_mfma_f32_16x16x32_bf16 v[56:59], a[56:59], v[136:139], v[56:59]
  v_cndmask_b32 v181, 0, v213, vcc
  v_cndmask_b32 v183, v213, 0, vcc
  v_cvt_pk_bf16_f32 v216, v216, v217
  v_cvt_pk_bf16_f32 v217, v218, v219
  v_mfma_f32_16x16x32_bf16 v[60:63], a[56:59], v[140:143], v[60:63]
  v_cndmask_b32 v184, 0, v216, vcc
  v_cndmask_b32 v186, v216, 0, vcc
  v_cndmask_b32 v185, 0, v217, vcc
  v_mfma_f32_16x16x32_bf16 v[64:67], a[60:63], v[128:131], v[64:67]
  v_cndmask_b32 v187, v217, 0, vcc
  v_cvt_pk_bf16_f32 v220, v220, v221
  buffer_load_dwordx4 v[92:95], v239, s[36:39], s3 offen sc1
  v_mfma_f32_16x16x32_bf16 v[68:71], a[60:63], v[132:135], v[68:71]
  v_cvt_pk_bf16_f32 v221, v222, v223
  v_cndmask_b32 v188, 0, v220, vcc
  v_cndmask_b32 v190, v220, 0, vcc
  v_mfma_f32_16x16x32_bf16 v[72:75], a[60:63], v[136:139], v[72:75]
  v_cndmask_b32 v189, 0, v221, vcc
  v_cndmask_b32 v191, v221, 0, vcc
  v_mov_b32 v204, 0x358637bd
  v_mfma_f32_16x16x32_bf16 v[76:79], a[60:63], v[140:143], v[76:79]
  v_mov_b32 v205, 0x358637bd
  v_mov_b32 v206, 0x358637bd
  v_mov_b32 v207, 0x358637bd
  s_nop 1
  s_waitcnt vmcnt(8)
  v_mfma_f32_16x16x32_bf16 v[200:203], v[176:179], v[144:147], v[204:207]
  v_mfma_f32_16x16x16_bf16 v[192:195], v[224:225], v[144:145], 0
  v_mfma_f32_16x16x16_bf16 v[196:199], v[226:227], v[146:147], 0
  s_barrier
  s_nop 4
  s_waitcnt vmcnt(4)
  v_mfma_f32_16x16x32_bf16 v[16:19], a[64:67], v[160:163], v[16:19]
  v_rcp_f32 v200, v200
  buffer_load_dwordx4 v[96:99], v236, s[36:39], s10 offen sc1
  v_rcp_f32 v201, v201
  v_mfma_f32_16x16x32_bf16 v[20:23], a[64:67], v[164:167], v[20:23]
  v_mul_f32 v192, v192, v200
  v_mul_f32 v193, v193, v200
  v_mfma_f32_16x16x32_bf16 v[216:219], v[176:179], v[148:151], v[204:207]
  v_mul_f32 v194, v194, v200
  v_mul_f32 v195, v195, v200
  v_mfma_f32_16x16x16_bf16 v[208:211], v[224:225], v[148:149], 0
  v_mul_f32 v196, v196, v201
  v_mul_f32 v197, v197, v201
  buffer_load_dwordx4 v[100:103], v237, s[36:39], s10 offen sc1
  v_mfma_f32_16x16x16_bf16 v[212:215], v[226:227], v[150:151], 0
  v_mul_f32 v198, v198, v201
  v_mul_f32 v199, v199, v201
  v_mfma_f32_16x16x32_bf16 v[24:27], a[64:67], v[168:171], v[24:27]
  v_cvt_pk_bf16_f32 v144, v192, v193
  v_cvt_pk_bf16_f32 v145, v194, v195
  v_mfma_f32_16x16x32_bf16 v[28:31], a[64:67], v[172:175], v[28:31]
  v_cvt_pk_bf16_f32 v146, v196, v197
  v_cvt_pk_bf16_f32 v147, v198, v199
  v_mfma_f32_16x16x32_bf16 v[32:35], a[68:71], v[160:163], v[32:35]
  v_rcp_f32 v216, v216
  v_mfma_f32_16x16x32_bf16 v[36:39], a[68:71], v[164:167], v[36:39]
  buffer_load_dwordx4 v[104:107], v238, s[36:39], s10 offen sc1
  v_mfma_f32_16x16x32_bf16 v[200:203], v[176:179], v[152:155], v[204:207]
  v_rcp_f32 v217, v217
  v_mfma_f32_16x16x16_bf16 v[192:195], v[224:225], v[152:153], 0
  v_mul_f32 v208, v208, v216
  v_mul_f32 v209, v209, v216
  v_mfma_f32_16x16x16_bf16 v[196:199], v[226:227], v[154:155], 0
  v_mul_f32 v210, v210, v216
  v_mul_f32 v211, v211, v216
  v_mfma_f32_16x16x32_bf16 v[16:19], a[176:179], v[144:147], v[16:19]
  v_mul_f32 v212, v212, v217
  v_mfma_f32_16x16x32_bf16 v[32:35], a[180:183], v[144:147], v[32:35]
  v_mul_f32 v213, v213, v217
  v_mfma_f32_16x16x32_bf16 v[48:51], a[184:187], v[144:147], v[48:51]
  buffer_load_dwordx4 v[108:111], v239, s[36:39], s10 offen sc1
  v_mfma_f32_16x16x32_bf16 v[64:67], a[188:191], v[144:147], v[64:67]
  v_mul_f32 v214, v214, v217
  v_mul_f32 v215, v215, v217
  v_mfma_f32_16x16x32_bf16 v[40:43], a[68:71], v[168:171], v[40:43]
  v_cvt_pk_bf16_f32 v148, v208, v209
  v_cvt_pk_bf16_f32 v149, v210, v211
  v_mfma_f32_16x16x32_bf16 v[44:47], a[68:71], v[172:175], v[44:47]
  v_cvt_pk_bf16_f32 v150, v212, v213
  v_cvt_pk_bf16_f32 v151, v214, v215
  v_mfma_f32_16x16x32_bf16 v[48:51], a[72:75], v[160:163], v[48:51]
  v_rcp_f32 v200, v200
  v_mfma_f32_16x16x32_bf16 v[52:55], a[72:75], v[164:167], v[52:55]
  s_add_u32 s3, s18, s78
  v_mfma_f32_16x16x32_bf16 v[216:219], v[176:179], v[156:159], v[204:207]
  v_rcp_f32 v201, v201
  v_mfma_f32_16x16x16_bf16 v[208:211], v[224:225], v[156:157], 0
  v_mul_f32 v192, v192, v200
  v_mul_f32 v193, v193, v200
  v_mfma_f32_16x16x16_bf16 v[212:215], v[226:227], v[158:159], 0
  v_mul_f32 v194, v194, v200
  v_mul_f32 v195, v195, v200
  v_mfma_f32_16x16x32_bf16 v[20:23], a[176:179], v[148:151], v[20:23]
  v_mul_f32 v196, v196, v201
  v_mul_f32 v197, v197, v201
  v_mfma_f32_16x16x32_bf16 v[36:39], a[180:183], v[148:151], v[36:39]
  buffer_load_dwordx4 v[112:115], v236, s[36:39], s3 offen sc1
  v_mfma_f32_16x16x32_bf16 v[52:55], a[184:187], v[148:151], v[52:55]
  v_mul_f32 v198, v198, v201
  v_mfma_f32_16x16x32_bf16 v[68:71], a[188:191], v[148:151], v[68:71]
  v_mul_f32 v199, v199, v201
  v_cvt_pk_bf16_f32 v152, v192, v193
  v_mfma_f32_16x16x32_bf16 v[56:59], a[72:75], v[168:171], v[56:59]
  v_cvt_pk_bf16_f32 v153, v194, v195
  v_cvt_pk_bf16_f32 v154, v196, v197
  v_mfma_f32_16x16x32_bf16 v[60:63], a[72:75], v[172:175], v[60:63]
  v_cvt_pk_bf16_f32 v155, v198, v199
  v_mfma_f32_16x16x32_bf16 v[64:67], a[76:79], v[160:163], v[64:67]
  v_rcp_f32 v216, v216
  v_mfma_f32_16x16x32_bf16 v[68:71], a[76:79], v[164:167], v[68:71]
  buffer_load_dwordx4 v[116:119], v237, s[36:39], s3 offen sc1
  s_waitcnt vmcnt(6)
  v_mfma_f32_16x16x32_bf16 v[200:203], v[180:183], v[80:83], v[204:207]
  v_rcp_f32 v217, v217
  v_mfma_f32_16x16x16_bf16 v[192:195], v[228:229], v[80:81], 0
  v_mul_f32 v208, v208, v216
  v_mul_f32 v209, v209, v216
  v_mfma_f32_16x16x16_bf16 v[196:199], v[230:231], v[82:83], 0
  v_mul_f32 v210, v210, v216
  v_mfma_f32_16x16x32_bf16 v[24:27], a[176:179], v[152:155], v[24:27]
  buffer_load_dwordx4 v[120:123], v238, s[36:39], s3 offen sc1
  v_mfma_f32_16x16x32_bf16 v[40:43], a[180:183], v[152:155], v[40:43]
  v_mul_f32 v211, v211, v216
  v_mul_f32 v212, v212, v217
  v_mfma_f32_16x16x32_bf16 v[56:59], a[184:187], v[152:155], v[56:59]
  v_mul_f32 v213, v213, v217
  v_mul_f32 v214, v214, v217
  v_mfma_f32_16x16x32_bf16 v[72:75], a[188:191], v[152:155], v[72:75]
  v_mul_f32 v215, v215, v217
  v_mfma_f32_16x16x32_bf16 v[72:75], a[76:79], v[168:171], v[72:75]
  buffer_load_dwordx4 v[124:127], v239, s[36:39], s3 offen sc1
  v_mfma_f32_16x16x32_bf16 v[76:79], a[76:79], v[172:175], v[76:79]
  v_cvt_pk_bf16_f32 v156, v208, v209
  v_cvt_pk_bf16_f32 v157, v210, v211
  v_cvt_pk_bf16_f32 v158, v212, v213
  v_cvt_pk_bf16_f32 v159, v214, v215
  s_waitcnt vmcnt(4)
  v_mfma_f32_16x16x32_bf16 v[16:19], a[80:83], v[96:99], v[16:19]
  v_rcp_f32 v200, v200
  v_mfma_f32_16x16x32_bf16 v[20:23], a[80:83], v[100:103], v[20:23]
  buffer_load_dwordx4 v[128:131], v236, s[36:39], s11 offen sc1
  v_mfma_f32_16x16x32_bf16 v[216:219], v[180:183], v[84:87], v[204:207]
  v_rcp_f32 v201, v201
  v_mfma_f32_16x16x16_bf16 v[208:211], v[228:229], v[84:85], 0
  v_mul_f32 v192, v192, v200
  v_mul_f32 v193, v193, v200
  v_mfma_f32_16x16x16_bf16 v[212:215], v[230:231], v[86:87], 0
  v_mul_f32 v194, v194, v200
  v_mul_f32 v195, v195, v200
  v_mfma_f32_16x16x32_bf16 v[28:31], a[176:179], v[156:159], v[28:31]
  v_mul_f32 v196, v196, v201
  v_mfma_f32_16x16x32_bf16 v[44:47], a[180:183], v[156:159], v[44:47]
  v_mul_f32 v197, v197, v201
  v_mfma_f32_16x16x32_bf16 v[60:63], a[184:187], v[156:159], v[60:63]
  buffer_load_dwordx4 v[132:135], v237, s[36:39], s11 offen sc1
  v_mfma_f32_16x16x32_bf16 v[76:79], a[188:191], v[156:159], v[76:79]
  v_mul_f32 v198, v198, v201
  v_mul_f32 v199, v199, v201
  v_mfma_f32_16x16x32_bf16 v[24:27], a[80:83], v[104:107], v[24:27]
  v_cvt_pk_bf16_f32 v80, v192, v193
  v_cvt_pk_bf16_f32 v81, v194, v195
  v_mfma_f32_16x16x32_bf16 v[28:31], a[80:83], v[108:111], v[28:31]
  v_cvt_pk_bf16_f32 v82, v196, v197
  v_cvt_pk_bf16_f32 v83, v198, v199
  v_mfma_f32_16x16x32_bf16 v[32:35], a[84:87], v[96:99], v[32:35]
  v_rcp_f32 v216, v216
  v_mfma_f32_16x16x32_bf16 v[36:39], a[84:87], v[100:103], v[36:39]
  buffer_load_dwordx4 v[136:139], v238, s[36:39], s11 offen sc1
  v_mfma_f32_16x16x32_bf16 v[200:203], v[180:183], v[88:91], v[204:207]
  v_rcp_f32 v217, v217
  v_mfma_f32_16x16x16_bf16 v[192:195], v[228:229], v[88:89], 0
  v_mul_f32 v208, v208, v216
  v_mul_f32 v209, v209, v216
  v_mfma_f32_16x16x16_bf16 v[196:199], v[230:231], v[90:91], 0
  v_mul_f32 v210, v210, v216
  v_mul_f32 v211, v211, v216
  v_mfma_f32_16x16x32_bf16 v[16:19], a[192:195], v[80:83], v[16:19]
  v_mul_f32 v212, v212, v217
  v_mfma_f32_16x16x32_bf16 v[32:35], a[196:199], v[80:83], v[32:35]
  v_mul_f32 v213, v213, v217
  v_mfma_f32_16x16x32_bf16 v[48:51], a[200:203], v[80:83], v[48:51]
  buffer_load_dwordx4 v[140:143], v239, s[36:39], s11 offen sc1
  v_mfma_f32_16x16x32_bf16 v[64:67], a[204:207], v[80:83], v[64:67]
  v_mul_f32 v214, v214, v217
  v_mul_f32 v215, v215, v217
  v_mfma_f32_16x16x32_bf16 v[40:43], a[84:87], v[104:107], v[40:43]
  v_cvt_pk_bf16_f32 v84, v208, v209
  v_cvt_pk_bf16_f32 v85, v210, v211
  v_mfma_f32_16x16x32_bf16 v[44:47], a[84:87], v[108:111], v[44:47]
  v_cvt_pk_bf16_f32 v86, v212, v213
  v_cvt_pk_bf16_f32 v87, v214, v215
  v_mfma_f32_16x16x32_bf16 v[48:51], a[88:91], v[96:99], v[48:51]
  v_rcp_f32 v200, v200
  v_mfma_f32_16x16x32_bf16 v[52:55], a[88:91], v[100:103], v[52:55]
  s_add_u32 s3, s19, s78
  v_mfma_f32_16x16x32_bf16 v[216:219], v[180:183], v[92:95], v[204:207]
  v_rcp_f32 v201, v201
  v_mfma_f32_16x16x16_bf16 v[208:211], v[228:229], v[92:93], 0
  v_mul_f32 v192, v192, v200
  v_mul_f32 v193, v193, v200
  v_mfma_f32_16x16x16_bf16 v[212:215], v[230:231], v[94:95], 0
  v_mul_f32 v194, v194, v200
  v_mul_f32 v195, v195, v200
  v_mfma_f32_16x16x32_bf16 v[20:23], a[192:195], v[84:87], v[20:23]
  v_mul_f32 v196, v196, v201
  v_mul_f32 v197, v197, v201
  v_mfma_f32_16x16x32_bf16 v[36:39], a[196:199], v[84:87], v[36:39]
  buffer_load_dwordx4 v[144:147], v236, s[36:39], s3 offen sc1
  v_mfma_f32_16x16x32_bf16 v[52:55], a[200:203], v[84:87], v[52:55]
  v_mul_f32 v198, v198, v201
  v_mfma_f32_16x16x32_bf16 v[68:71], a[204:207], v[84:87], v[68:71]
  v_mul_f32 v199, v199, v201
  v_cvt_pk_bf16_f32 v88, v192, v193
  v_mfma_f32_16x16x32_bf16 v[56:59], a[88:91], v[104:107], v[56:59]
  v_cvt_pk_bf16_f32 v89, v194, v195
  v_cvt_pk_bf16_f32 v90, v196, v197
  v_mfma_f32_16x16x32_bf16 v[60:63], a[88:91], v[108:111], v[60:63]
  v_cvt_pk_bf16_f32 v91, v198, v199
  v_mfma_f32_16x16x32_bf16 v[64:67], a[92:95], v[96:99], v[64:67]
  v_rcp_f32 v216, v216
  v_mfma_f32_16x16x32_bf16 v[68:71], a[92:95], v[100:103], v[68:71]
  buffer_load_dwordx4 v[148:151], v237, s[36:39], s3 offen sc1
  s_waitcnt vmcnt(6)
  v_mfma_f32_16x16x32_bf16 v[200:203], v[184:187], v[112:115], v[204:207]
  v_rcp_f32 v217, v217
  v_mfma_f32_16x16x16_bf16 v[192:195], v[232:233], v[112:113], 0
  v_mul_f32 v208, v208, v216
  v_mul_f32 v209, v209, v216
  v_mfma_f32_16x16x16_bf16 v[196:199], v[234:235], v[114:115], 0
  v_mul_f32 v210, v210, v216
  v_mfma_f32_16x16x32_bf16 v[24:27], a[192:195], v[88:91], v[24:27]
  buffer_load_dwordx4 v[152:155], v238, s[36:39], s3 offen sc1
  v_mfma_f32_16x16x32_bf16 v[40:43], a[196:199], v[88:91], v[40:43]
  v_mul_f32 v211, v211, v216
  v_mul_f32 v212, v212, v217
  v_mfma_f32_16x16x32_bf16 v[56:59], a[200:203], v[88:91], v[56:59]
  v_mul_f32 v213, v213, v217
  v_mul_f32 v214, v214, v217
  v_mfma_f32_16x16x32_bf16 v[72:75], a[204:207], v[88:91], v[72:75]
  v_mul_f32 v215, v215, v217
  v_mfma_f32_16x16x32_bf16 v[72:75], a[92:95], v[104:107], v[72:75]
  buffer_load_dwordx4 v[156:159], v239, s[36:39], s3 offen sc1
  v_mfma_f32_16x16x32_bf16 v[76:79], a[92:95], v[108:111], v[76:79]
  v_cvt_pk_bf16_f32 v92, v208, v209
  v_cvt_pk_bf16_f32 v93, v210, v211
  v_cvt_pk_bf16_f32 v94, v212, v213
  v_cvt_pk_bf16_f32 v95, v214, v215
  s_waitcnt vmcnt(4)
  v_mfma_f32_16x16x32_bf16 v[16:19], a[96:99], v[128:131], v[16:19]
  v_rcp_f32 v200, v200
  v_mfma_f32_16x16x32_bf16 v[20:23], a[96:99], v[132:135], v[20:23]
  buffer_load_dwordx4 v[160:163], v236, s[36:39], s12 offen sc1
  v_mfma_f32_16x16x32_bf16 v[216:219], v[184:187], v[116:119], v[204:207]
  v_rcp_f32 v201, v201
  v_mfma_f32_16x16x16_bf16 v[208:211], v[232:233], v[116:117], 0
  v_mul_f32 v192, v192, v200
  v_mul_f32 v193, v193, v200
  v_mfma_f32_16x16x16_bf16 v[212:215], v[234:235], v[118:119], 0
  v_mul_f32 v194, v194, v200
  v_mul_f32 v195, v195, v200
  v_mfma_f32_16x16x32_bf16 v[28:31], a[192:195], v[92:95], v[28:31]
  v_mul_f32 v196, v196, v201
  v_mfma_f32_16x16x32_bf16 v[44:47], a[196:199], v[92:95], v[44:47]
  v_mul_f32 v197, v197, v201
  v_mfma_f32_16x16x32_bf16 v[60:63], a[200:203], v[92:95], v[60:63]
  buffer_load_dwordx4 v[164:167], v237, s[36:39], s12 offen sc1
  v_mfma_f32_16x16x32_bf16 v[76:79], a[204:207], v[92:95], v[76:79]
  v_mul_f32 v198, v198, v201
  v_mul_f32 v199, v199, v201
  v_mfma_f32_16x16x32_bf16 v[24:27], a[96:99], v[136:139], v[24:27]
  v_cvt_pk_bf16_f32 v112, v192, v193
  v_cvt_pk_bf16_f32 v113, v194, v195
  v_mfma_f32_16x16x32_bf16 v[28:31], a[96:99], v[140:143], v[28:31]
  v_cvt_pk_bf16_f32 v114, v196, v197
  v_cvt_pk_bf16_f32 v115, v198, v199
  v_mfma_f32_16x16x32_bf16 v[32:35], a[100:103], v[128:131], v[32:35]
  v_rcp_f32 v216, v216
  v_mfma_f32_16x16x32_bf16 v[36:39], a[100:103], v[132:135], v[36:39]
  buffer_load_dwordx4 v[168:171], v238, s[36:39], s12 offen sc1
  v_mfma_f32_16x16x32_bf16 v[200:203], v[184:187], v[120:123], v[204:207]
  v_rcp_f32 v217, v217
  v_mfma_f32_16x16x16_bf16 v[192:195], v[232:233], v[120:121], 0
  v_mul_f32 v208, v208, v216
  v_mul_f32 v209, v209, v216
  v_mfma_f32_16x16x16_bf16 v[196:199], v[234:235], v[122:123], 0
  v_mul_f32 v210, v210, v216
  v_mul_f32 v211, v211, v216
  v_mfma_f32_16x16x32_bf16 v[16:19], a[208:211], v[112:115], v[16:19]
  v_mul_f32 v212, v212, v217
  v_mfma_f32_16x16x32_bf16 v[32:35], a[212:215], v[112:115], v[32:35]
  v_mul_f32 v213, v213, v217
  v_mfma_f32_16x16x32_bf16 v[48:51], a[216:219], v[112:115], v[48:51]
  buffer_load_dwordx4 v[172:175], v239, s[36:39], s12 offen sc1
  v_mfma_f32_16x16x32_bf16 v[64:67], a[220:223], v[112:115], v[64:67]
  v_mul_f32 v214, v214, v217
  v_mul_f32 v215, v215, v217
  v_mfma_f32_16x16x32_bf16 v[40:43], a[100:103], v[136:139], v[40:43]
  v_cvt_pk_bf16_f32 v116, v208, v209
  v_cvt_pk_bf16_f32 v117, v210, v211
  v_mfma_f32_16x16x32_bf16 v[44:47], a[100:103], v[140:143], v[44:47]
  v_cvt_pk_bf16_f32 v118, v212, v213
  v_cvt_pk_bf16_f32 v119, v214, v215
  v_mfma_f32_16x16x32_bf16 v[48:51], a[104:107], v[128:131], v[48:51]
  v_rcp_f32 v200, v200
  v_mfma_f32_16x16x32_bf16 v[52:55], a[104:107], v[132:135], v[52:55]
  buffer_load_dwordx4 v[80:83], v236, s[36:39], s13 offen sc1
  v_mfma_f32_16x16x32_bf16 v[216:219], v[184:187], v[124:127], v[204:207]
  v_rcp_f32 v201, v201
  v_mfma_f32_16x16x16_bf16 v[208:211], v[232:233], v[124:125], 0
  v_mul_f32 v192, v192, v200
  v_mul_f32 v193, v193, v200
  v_mfma_f32_16x16x16_bf16 v[212:215], v[234:235], v[126:127], 0
  v_mul_f32 v194, v194, v200
  v_mul_f32 v195, v195, v200
  v_mfma_f32_16x16x32_bf16 v[20:23], a[208:211], v[116:119], v[20:23]
  v_mul_f32 v196, v196, v201
  v_mfma_f32_16x16x32_bf16 v[36:39], a[212:215], v[116:119], v[36:39]
  v_mul_f32 v197, v197, v201
  v_mfma_f32_16x16x32_bf16 v[52:55], a[216:219], v[116:119], v[52:55]
  buffer_load_dwordx4 v[84:87], v237, s[36:39], s13 offen sc1
  v_mfma_f32_16x16x32_bf16 v[68:71], a[220:223], v[116:119], v[68:71]
  v_mul_f32 v198, v198, v201
  v_mul_f32 v199, v199, v201
  v_mfma_f32_16x16x32_bf16 v[56:59], a[104:107], v[136:139], v[56:59]
  v_cvt_pk_bf16_f32 v120, v192, v193
  v_cvt_pk_bf16_f32 v121, v194, v195
  v_mfma_f32_16x16x32_bf16 v[60:63], a[104:107], v[140:143], v[60:63]
  v_cvt_pk_bf16_f32 v122, v196, v197
  v_cvt_pk_bf16_f32 v123, v198, v199
  v_mfma_f32_16x16x32_bf16 v[64:67], a[108:111], v[128:131], v[64:67]
  v_rcp_f32 v216, v216
  v_mfma_f32_16x16x32_bf16 v[68:71], a[108:111], v[132:135], v[68:71]
  buffer_load_dwordx4 v[88:91], v238, s[36:39], s13 offen sc1
  s_waitcnt vmcnt(7)
  v_mfma_f32_16x16x32_bf16 v[200:203], v[188:191], v[144:147], v[204:207]
  v_rcp_f32 v217, v217
  v_mfma_f32_16x16x16_bf16 v[192:195], v[248:249], v[144:145], 0
  v_mul_f32 v208, v208, v216
  v_mul_f32 v209, v209, v216
  v_mfma_f32_16x16x16_bf16 v[196:199], v[250:251], v[146:147], 0
  v_mul_f32 v210, v210, v216
  v_mul_f32 v211, v211, v216
  v_mfma_f32_16x16x32_bf16 v[24:27], a[208:211], v[120:123], v[24:27]
  v_mul_f32 v212, v212, v217
  v_mfma_f32_16x16x32_bf16 v[40:43], a[212:215], v[120:123], v[40:43]
  v_mul_f32 v213, v213, v217
  v_mfma_f32_16x16x32_bf16 v[56:59], a[216:219], v[120:123], v[56:59]
  buffer_load_dwordx4 v[92:95], v239, s[36:39], s13 offen sc1
  v_mfma_f32_16x16x32_bf16 v[72:75], a[220:223], v[120:123], v[72:75]
  v_mul_f32 v214, v214, v217
  v_mul_f32 v215, v215, v217
  v_mfma_f32_16x16x32_bf16 v[72:75], a[108:111], v[136:139], v[72:75]
  v_cvt_pk_bf16_f32 v124, v208, v209
  v_cvt_pk_bf16_f32 v125, v210, v211
  v_mfma_f32_16x16x32_bf16 v[76:79], a[108:111], v[140:143], v[76:79]
  v_cvt_pk_bf16_f32 v126, v212, v213
  v_cvt_pk_bf16_f32 v127, v214, v215
  s_waitcnt vmcnt(4)
  v_mfma_f32_16x16x32_bf16 v[16:19], a[112:115], v[160:163], v[16:19]
  v_rcp_f32 v200, v200
  v_mfma_f32_16x16x32_bf16 v[20:23], a[112:115], v[164:167], v[20:23]
  buffer_load_dwordx4 v[96:99], v236, s[36:39], s14 offen sc1
  v_mfma_f32_16x16x32_bf16 v[216:219], v[188:191], v[148:151], v[204:207]
  v_rcp_f32 v201, v201
  v_mfma_f32_16x16x16_bf16 v[208:211], v[248:249], v[148:149], 0
  v_mul_f32 v192, v192, v200
  v_mul_f32 v193, v193, v200
  v_mfma_f32_16x16x16_bf16 v[212:215], v[250:251], v[150:151], 0
  v_mul_f32 v194, v194, v200
  v_mul_f32 v195, v195, v200
  v_mfma_f32_16x16x32_bf16 v[28:31], a[208:211], v[124:127], v[28:31]
  v_mul_f32 v196, v196, v201
  v_mfma_f32_16x16x32_bf16 v[44:47], a[212:215], v[124:127], v[44:47]
  v_mul_f32 v197, v197, v201
  v_mfma_f32_16x16x32_bf16 v[60:63], a[216:219], v[124:127], v[60:63]
  buffer_load_dwordx4 v[100:103], v237, s[36:39], s14 offen sc1
  v_mfma_f32_16x16x32_bf16 v[76:79], a[220:223], v[124:127], v[76:79]
  v_mul_f32 v198, v198, v201
  v_mul_f32 v199, v199, v201
  v_mfma_f32_16x16x32_bf16 v[24:27], a[112:115], v[168:171], v[24:27]
  v_cvt_pk_bf16_f32 v144, v192, v193
  v_cvt_pk_bf16_f32 v145, v194, v195
  v_mfma_f32_16x16x32_bf16 v[28:31], a[112:115], v[172:175], v[28:31]
  v_cvt_pk_bf16_f32 v146, v196, v197
  v_cvt_pk_bf16_f32 v147, v198, v199
  v_mfma_f32_16x16x32_bf16 v[32:35], a[116:119], v[160:163], v[32:35]
  v_rcp_f32 v216, v216
  v_mfma_f32_16x16x32_bf16 v[36:39], a[116:119], v[164:167], v[36:39]
  buffer_load_dwordx4 v[104:107], v238, s[36:39], s14 offen sc1
  v_mfma_f32_16x16x32_bf16 v[200:203], v[188:191], v[152:155], v[204:207]
  v_rcp_f32 v217, v217
  v_mfma_f32_16x16x16_bf16 v[192:195], v[248:249], v[152:153], 0
  v_mul_f32 v208, v208, v216
  v_mul_f32 v209, v209, v216
  v_mfma_f32_16x16x16_bf16 v[196:199], v[250:251], v[154:155], 0
  v_mul_f32 v210, v210, v216
  v_mul_f32 v211, v211, v216
  v_mfma_f32_16x16x32_bf16 v[16:19], a[224:227], v[144:147], v[16:19]
  v_mul_f32 v212, v212, v217
  v_mfma_f32_16x16x32_bf16 v[32:35], a[228:231], v[144:147], v[32:35]
  v_mul_f32 v213, v213, v217
  v_mfma_f32_16x16x32_bf16 v[48:51], a[232:235], v[144:147], v[48:51]
  buffer_load_dwordx4 v[108:111], v239, s[36:39], s14 offen sc1
  v_mfma_f32_16x16x32_bf16 v[64:67], a[236:239], v[144:147], v[64:67]
  v_mul_f32 v214, v214, v217
  v_mul_f32 v215, v215, v217
  v_mfma_f32_16x16x32_bf16 v[40:43], a[116:119], v[168:171], v[40:43]
  v_cvt_pk_bf16_f32 v148, v208, v209
  v_cvt_pk_bf16_f32 v149, v210, v211
  v_mfma_f32_16x16x32_bf16 v[44:47], a[116:119], v[172:175], v[44:47]
  v_cvt_pk_bf16_f32 v150, v212, v213
  v_cvt_pk_bf16_f32 v151, v214, v215
  v_mfma_f32_16x16x32_bf16 v[48:51], a[120:123], v[160:163], v[48:51]
  v_rcp_f32 v200, v200
  v_mfma_f32_16x16x32_bf16 v[52:55], a[120:123], v[164:167], v[52:55]
  buffer_load_dwordx4 v[112:115], v236, s[36:39], s15 offen sc1
  v_mfma_f32_16x16x32_bf16 v[216:219], v[188:191], v[156:159], v[204:207]
  v_rcp_f32 v201, v201
  v_mfma_f32_16x16x16_bf16 v[208:211], v[248:249], v[156:157], 0
  v_mul_f32 v192, v192, v200
  v_mul_f32 v193, v193, v200
  v_mfma_f32_16x16x16_bf16 v[212:215], v[250:251], v[158:159], 0
  v_mul_f32 v194, v194, v200
  v_mul_f32 v195, v195, v200
  v_mfma_f32_16x16x32_bf16 v[20:23], a[224:227], v[148:151], v[20:23]
  v_mul_f32 v196, v196, v201
  v_mfma_f32_16x16x32_bf16 v[36:39], a[228:231], v[148:151], v[36:39]
  v_mul_f32 v197, v197, v201
  v_mfma_f32_16x16x32_bf16 v[52:55], a[232:235], v[148:151], v[52:55]
  buffer_load_dwordx4 v[116:119], v237, s[36:39], s15 offen sc1
  v_mfma_f32_16x16x32_bf16 v[68:71], a[236:239], v[148:151], v[68:71]
  v_mul_f32 v198, v198, v201
  v_mul_f32 v199, v199, v201
  v_mfma_f32_16x16x32_bf16 v[56:59], a[120:123], v[168:171], v[56:59]
  v_cvt_pk_bf16_f32 v152, v192, v193
  v_cvt_pk_bf16_f32 v153, v194, v195
  v_mfma_f32_16x16x32_bf16 v[60:63], a[120:123], v[172:175], v[60:63]
  v_cvt_pk_bf16_f32 v154, v196, v197
  v_cvt_pk_bf16_f32 v155, v198, v199
  v_mfma_f32_16x16x32_bf16 v[64:67], a[124:127], v[160:163], v[64:67]
  v_rcp_f32 v216, v216
  buffer_load_dwordx4 v[120:123], v238, s[36:39], s15 offen sc1
  v_mfma_f32_16x16x32_bf16 v[68:71], a[124:127], v[164:167], v[68:71]
  v_rcp_f32 v217, v217
  v_mul_f32 v208, v208, v216
  v_mfma_f32_16x16x32_bf16 v[24:27], a[224:227], v[152:155], v[24:27]
  v_mul_f32 v209, v209, v216
  v_mul_f32 v210, v210, v216
  v_mfma_f32_16x16x32_bf16 v[40:43], a[228:231], v[152:155], v[40:43]
  v_mul_f32 v211, v211, v216
  v_mul_f32 v212, v212, v217
  v_mfma_f32_16x16x32_bf16 v[56:59], a[232:235], v[152:155], v[56:59]
  v_mul_f32 v213, v213, v217
  buffer_load_dwordx4 v[124:127], v239, s[36:39], s15 offen sc1
  v_mfma_f32_16x16x32_bf16 v[72:75], a[236:239], v[152:155], v[72:75]
  v_mul_f32 v214, v214, v217
  v_mul_f32 v215, v215, v217
  v_mfma_f32_16x16x32_bf16 v[72:75], a[124:127], v[168:171], v[72:75]
  v_cvt_pk_bf16_f32 v156, v208, v209
  v_cvt_pk_bf16_f32 v157, v210, v211
  v_mfma_f32_16x16x32_bf16 v[76:79], a[124:127], v[172:175], v[76:79]
  v_cvt_pk_bf16_f32 v158, v212, v213
  v_cvt_pk_bf16_f32 v159, v214, v215
  s_waitcnt vmcnt(8)
  v_mfma_f32_16x16x32_bf16 v[16:19], a[128:131], v[80:83], v[16:19]
  v_mfma_f32_16x16x32_bf16 v[20:23], a[128:131], v[84:87], v[20:23]
  v_mfma_f32_16x16x32_bf16 v[24:27], a[128:131], v[88:91], v[24:27]
  v_mfma_f32_16x16x32_bf16 v[28:31], a[128:131], v[92:95], v[28:31]
  v_mfma_f32_16x16x32_bf16 v[32:35], a[132:135], v[80:83], v[32:35]
  v_mfma_f32_16x16x32_bf16 v[36:39], a[132:135], v[84:87], v[36:39]
  v_mfma_f32_16x16x32_bf16 v[40:43], a[132:135], v[88:91], v[40:43]
  v_mfma_f32_16x16x32_bf16 v[44:47], a[132:135], v[92:95], v[44:47]
  v_mfma_f32_16x16x32_bf16 v[48:51], a[136:139], v[80:83], v[48:51]
  v_mfma_f32_16x16x32_bf16 v[52:55], a[136:139], v[84:87], v[52:55]
  v_mfma_f32_16x16x32_bf16 v[56:59], a[136:139], v[88:91], v[56:59]
  v_mfma_f32_16x16x32_bf16 v[60:63], a[136:139], v[92:95], v[60:63]
  v_mfma_f32_16x16x32_bf16 v[64:67], a[140:143], v[80:83], v[64:67]
  v_mfma_f32_16x16x32_bf16 v[68:71], a[140:143], v[84:87], v[68:71]
  v_mfma_f32_16x16x32_bf16 v[72:75], a[140:143], v[88:91], v[72:75]
  v_mfma_f32_16x16x32_bf16 v[76:79], a[140:143], v[92:95], v[76:79]
  s_waitcnt vmcnt(0)
  v_mfma_f32_16x16x32_bf16 v[16:19], a[144:147], v[96:99], v[16:19]
  v_lshlrev_b32 v176, 16, v240
  v_mfma_f32_16x16x32_bf16 v[32:35], a[148:151], v[96:99], v[32:35]
  v_and_b32 v177, 0xffff0000, v240
  v_mfma_f32_16x16x32_bf16 v[48:51], a[152:155], v[96:99], v[48:51]
  v_lshlrev_b32 v178, 16, v241
  v_mfma_f32_16x16x32_bf16 v[64:67], a[156:159], v[96:99], v[64:67]
  v_and_b32 v179, 0xffff0000, v241
  v_mfma_f32_16x16x32_bf16 v[16:19], a[160:163], v[112:115], v[16:19]
  v_lshlrev_b32 v180, 16, v242
  v_mfma_f32_16x16x32_bf16 v[32:35], a[164:167], v[112:115], v[32:35]
  v_and_b32 v181, 0xffff0000, v242
  v_mfma_f32_16x16x32_bf16 v[48:51], a[168:171], v[112:115], v[48:51]
  v_lshlrev_b32 v182, 16, v243
  v_mfma_f32_16x16x32_bf16 v[64:67], a[172:175], v[112:115], v[64:67]
  v_and_b32 v183, 0xffff0000, v243
  v_mfma_f32_16x16x32_bf16 v[20:23], a[144:147], v[100:103], v[20:23]
  v_lshlrev_b32 v184, 16, v244
  v_mfma_f32_16x16x32_bf16 v[36:39], a[148:151], v[100:103], v[36:39]
  v_and_b32 v185, 0xffff0000, v244
  v_mfma_f32_16x16x32_bf16 v[52:55], a[152:155], v[100:103], v[52:55]
  v_lshlrev_b32 v186, 16, v245
  v_mfma_f32_16x16x32_bf16 v[68:71], a[156:159], v[100:103], v[68:71]
  v_and_b32 v187, 0xffff0000, v245
  v_mfma_f32_16x16x32_bf16 v[20:23], a[160:163], v[116:119], v[20:23]
  v_lshlrev_b32 v188, 16, v246
  v_mfma_f32_16x16x32_bf16 v[36:39], a[164:167], v[116:119], v[36:39]
  v_and_b32 v189, 0xffff0000, v246
  v_mfma_f32_16x16x32_bf16 v[52:55], a[168:171], v[116:119], v[52:55]
  v_lshlrev_b32 v190, 16, v247
  v_mfma_f32_16x16x32_bf16 v[68:71], a[172:175], v[116:119], v[68:71]
  v_and_b32 v191, 0xffff0000, v247
  v_mfma_f32_16x16x32_bf16 v[24:27], a[144:147], v[104:107], v[24:27]
  ds_write_b128 v2, v[16:19] offset:0
  v_mfma_f32_16x16x32_bf16 v[40:43], a[148:151], v[104:107], v[40:43]
  v_mfma_f32_16x16x32_bf16 v[56:59], a[152:155], v[104:107], v[56:59]
  ds_write_b128 v2, v[32:35] offset:1024
  v_mfma_f32_16x16x32_bf16 v[72:75], a[156:159], v[104:107], v[72:75]
  v_mfma_f32_16x16x32_bf16 v[24:27], a[160:163], v[120:123], v[24:27]
  ds_write_b128 v2, v[48:51] offset:2048
  v_mfma_f32_16x16x32_bf16 v[40:43], a[164:167], v[120:123], v[40:43]
  v_mfma_f32_16x16x32_bf16 v[56:59], a[168:171], v[120:123], v[56:59]
  ds_write_b128 v2, v[64:67] offset:3072
  v_mfma_f32_16x16x32_bf16 v[72:75], a[172:175], v[120:123], v[72:75]
  v_mfma_f32_16x16x32_bf16 v[28:31], a[144:147], v[108:111], v[28:31]
  ds_write_b128 v3, v[20:23] offset:0
  v_mfma_f32_16x16x32_bf16 v[44:47], a[148:151], v[108:111], v[44:47]
  v_mfma_f32_16x16x32_bf16 v[60:63], a[152:155], v[108:111], v[60:63]
  ds_write_b128 v3, v[36:39] offset:1024
  v_mfma_f32_16x16x32_bf16 v[76:79], a[156:159], v[108:111], v[76:79]
  v_mfma_f32_16x16x32_bf16 v[28:31], a[160:163], v[124:127], v[28:31]
  ds_write_b128 v3, v[52:55] offset:2048
  v_mfma_f32_16x16x32_bf16 v[44:47], a[164:167], v[124:127], v[44:47]
  v_mfma_f32_16x16x32_bf16 v[60:63], a[168:171], v[124:127], v[60:63]
  ds_write_b128 v3, v[68:71] offset:3072
  v_mfma_f32_16x16x32_bf16 v[76:79], a[172:175], v[124:127], v[76:79]
  v_mfma_f32_16x16x32_bf16 v[28:31], a[224:227], v[156:159], v[28:31]
  ds_write_b128 v4, v[24:27] offset:0
  v_mfma_f32_16x16x32_bf16 v[44:47], a[228:231], v[156:159], v[44:47]
  ds_write_b128 v4, v[40:43] offset:1024
  v_mfma_f32_16x16x32_bf16 v[60:63], a[232:235], v[156:159], v[60:63]
  ds_write_b128 v4, v[56:59] offset:2048
  v_mfma_f32_16x16x32_bf16 v[76:79], a[236:239], v[156:159], v[76:79]
  ds_write_b128 v4, v[72:75] offset:3072
  s_waitcnt lgkmcnt(0)
  s_barrier
  ds_read_b128 v[96:99], v8 offset:0
  ds_read_b128 v[100:103], v8 offset:4096
  ds_read_b128 v[104:107], v8 offset:8192
  ds_read_b128 v[108:111], v8 offset:1024
  ds_read_b128 v[112:115], v8 offset:5120
  ds_read_b128 v[116:119], v8 offset:9216
  ds_read_b128 v[120:123], v8 offset:2048
  ds_read_b128 v[124:127], v8 offset:6144
  ds_read_b128 v[128:131], v8 offset:10240
  ds_read_b128 v[132:135], v8 offset:3072
  ds_read_b128 v[136:139], v8 offset:7168
  ds_read_b128 v[140:143], v8 offset:11264
  v_pk_add_f32 v[28:29], v[28:29], v[176:177]
  v_pk_add_f32 v[30:31], v[30:31], v[178:179]
  v_pk_add_f32 v[44:45], v[44:45], v[180:181]
  v_pk_add_f32 v[46:47], v[46:47], v[182:183]
  v_pk_add_f32 v[60:61], v[60:61], v[184:185]
  v_pk_add_f32 v[62:63], v[62:63], v[186:187]
  v_pk_add_f32 v[76:77], v[76:77], v[188:189]
  v_pk_add_f32 v[78:79], v[78:79], v[190:191]
  s_waitcnt lgkmcnt(6)
  v_pk_add_f32 v[96:97], v[96:97], v[100:101]
  v_pk_add_f32 v[98:99], v[98:99], v[102:103]
  v_pk_add_f32 v[28:29], v[28:29], v[104:105]
  v_pk_add_f32 v[30:31], v[30:31], v[106:107]
  v_pk_add_f32 v[108:109], v[108:109], v[112:113]
  v_pk_add_f32 v[110:111], v[110:111], v[114:115]
  v_pk_add_f32 v[44:45], v[44:45], v[116:117]
  v_pk_add_f32 v[46:47], v[46:47], v[118:119]
  v_pk_add_f32 v[28:29], v[28:29], v[96:97]
  v_pk_add_f32 v[30:31], v[30:31], v[98:99]
  v_pk_add_f32 v[44:45], v[44:45], v[108:109]
  v_pk_add_f32 v[46:47], v[46:47], v[110:111]
  v_cvt_pk_bf16_f32 v160, v28, v29
  v_cvt_pk_bf16_f32 v161, v30, v31
  v_cvt_pk_bf16_f32 v162, v44, v45
  v_cvt_pk_bf16_f32 v163, v46, v47
  s_nop 1
  v_permlane16_swap_b32 v160, v162
  v_permlane16_swap_b32 v161, v163
  s_nop 0
  buffer_store_dwordx4 v[160:163], v15, s[48:51], s93 offen offset:0
  s_waitcnt lgkmcnt(0)
  v_pk_add_f32 v[120:121], v[120:121], v[124:125]
  v_pk_add_f32 v[122:123], v[122:123], v[126:127]
  v_pk_add_f32 v[60:61], v[60:61], v[128:129]
  v_pk_add_f32 v[62:63], v[62:63], v[130:131]
  v_pk_add_f32 v[132:133], v[132:133], v[136:137]
  v_pk_add_f32 v[134:135], v[134:135], v[138:139]
  v_pk_add_f32 v[76:77], v[76:77], v[140:141]
  v_pk_add_f32 v[78:79], v[78:79], v[142:143]
  v_pk_add_f32 v[60:61], v[60:61], v[120:121]
  v_pk_add_f32 v[62:63], v[62:63], v[122:123]
  v_pk_add_f32 v[76:77], v[76:77], v[132:133]
  v_pk_add_f32 v[78:79], v[78:79], v[134:135]
  v_cvt_pk_bf16_f32 v164, v60, v61
  v_cvt_pk_bf16_f32 v165, v62, v63
  v_cvt_pk_bf16_f32 v166, v76, v77
  v_cvt_pk_bf16_f32 v167, v78, v79
  s_nop 1
  v_permlane16_swap_b32 v164, v166
  v_permlane16_swap_b32 v165, v167
  s_nop 0
  buffer_store_dwordx4 v[164:167], v15, s[48:51], s93 offen offset:64
L_end:
  s_endpgm
L_code_end:
.section .rodata,"a"
.p2align 6
.amdhsa_kernel parallel_sum__linear_attn_block__dense_activation_relu__prompt_kernel
  .amdhsa_next_free_vgpr 512
  .amdhsa_next_free_sgpr 102
  .amdhsa_accum_offset 256
  .amdhsa_group_segment_fixed_size 0
  .amdhsa_kernarg_size 72
  .amdhsa_user_sgpr_count 2
  .amdhsa_user_sgpr_kernarg_segment_ptr 1
  .amdhsa_system_sgpr_workgroup_id_x 1
.end_amdhsa_kernel
.text
```
